```python
import torch

def _softmax(x, axis=-1):
    return torch.softmax(x, dim=axis)
def _gelu(x):
    return torch.nn.functional.gelu(x, approximate="tanh")
def _silu(x):
    return torch.nn.functional.silu(x)
def _sigmoid(x):
    return torch.sigmoid(x)
def _layernorm(x, axis=-1, eps=1e-5):
    m = x.mean(dim=axis, keepdim=True)
    v = x.var(dim=axis, keepdim=True, unbiased=False)
    return (x - m) / torch.sqrt(v + eps)
def _scatter_add(tgt, idx, src, axis=0):
    return tgt.clone().index_add_(axis, idx, src)
def _segment_sum(src, seg, n):
    out = torch.zeros((n,) + src.shape[1:], dtype=src.dtype)
    return out.index_add_(0, seg, src)
def _pad(x, pw):
    flat = tuple(v for pair in reversed(pw) for v in pair)
    return torch.nn.functional.pad(x, flat)

kernel_name = 'gated_mix__softmax_full_mha__geglu_ffn__prompt'

def setup_inputs():

    _w = (lambda a: (lambda t: t.to(torch.bfloat16) if t.is_floating_point() else t)(torch.as_tensor(a)))
    def _A_setup():
        B, S, D = 1, 2048, 640
        return {
            "x": _w((lambda *s: torch.randn(*s, dtype=torch.bfloat16) * 0.05)(B, S, D)),
            "wqkv": _w((lambda *s: torch.randn(*s, dtype=torch.bfloat16) * 0.8)(D, 3 * D)),
            "wo": _w((lambda *s: torch.randn(*s, dtype=torch.bfloat16) * 0.05)(D, D)),
        }
    _A_in = _A_setup()

    def _B_setup():
        B, S, D, F = 1, 2048, 640, 1728
        return {
            "x": _w((lambda *s: torch.randn(*s, dtype=torch.bfloat16) * 0.05)(B, S, D)),
            "w_gate": _w((lambda *s: torch.randn(*s, dtype=torch.bfloat16) * 0.1)(D, F)),
            "w_up": _w((lambda *s: torch.randn(*s, dtype=torch.bfloat16) * 0.1)(D, F)),
            "w_down": _w((lambda *s: torch.randn(*s, dtype=torch.bfloat16) * 0.1)(F, D)),
        }
    _B_in = _B_setup()

    return {
        "A_x": _A_in["x"],
        "A_wqkv": _A_in["wqkv"],
        "A_wo": _A_in["wo"],
        "B_x": _B_in["x"],
        "B_w_gate": _B_in["w_gate"],
        "B_w_up": _B_in["w_up"],
        "B_w_down": _B_in["w_down"],
        "gate_w": _w((lambda *s: torch.randn(*s, dtype=torch.bfloat16) * 0.05)(640) * 16.0),
    }

def reference(A_x, A_wqkv, A_wo, B_x, B_w_gate, B_w_up, B_w_down, gate_w):
    def _A_ref(x, wqkv, wo):
        B, S, D = x.shape
        H = 32; Dh = D // H
        qkv = (lambda x, *d: x.permute(*d))((x @ wqkv).reshape(B, S, 3, H, Dh), 2, 0, 3, 1, 4)
        q, k, v = qkv[0], qkv[1], qkv[2]
        scale = Dh ** -0.5
        scores = torch.einsum("bhqd,bhkd->bhqk", q, k) * scale
        p = _softmax(scores, axis=-1)
        o = torch.einsum("bhqk,bhkd->bhqd", p, v)
        return (lambda x, *d: x.permute(*d))(o, 0, 2, 1, 3).reshape(B, S, D) @ wo

    def _B_ref(x, w_gate, w_up, w_down):
        return (_gelu(x @ w_gate) * (x @ w_up)) @ w_down

    x = A_x
    g = _sigmoid((x * gate_w).sum(-1, keepdims=True))
    a = _A_ref(x, A_wqkv, A_wo)
    b = _B_ref(x, B_w_gate, B_w_up, B_w_down)
    return g * a + (1 - g) * b
```

```asm
; @launch kernel=kf_kernel grid=(256,1,1) block=(768,1,1) lds=163840
.amdgcn_target "amdgcn-amd-amdhsa--gfx950"
.text
.globl kf_kernel
.p2align 8
.type kf_kernel,@function
kf_kernel:
    s_cmp_ge_u32 s2, 256
    s_cbranch_scc0 L_go
    s_endpgm
L_go:
    s_load_dwordx8 s[64:71], s[0:1], 0
    s_load_dwordx8 s[72:79], s[0:1], 32
    s_load_dwordx4 s[80:83], s[0:1], 64
    s_load_dwordx2 s[84:85], s[0:1], 80
    v_lshrrev_b32 v1, 6, v0
    v_and_b32 v0, 63, v0
    v_readfirstlane_b32 s12, v1
    s_and_b32 s25, s2, 7
    s_lshr_b32 s24, s2, 6
    s_lshl_b32 s13, s25, 2
    s_add_u32 s13, s13, s24
    s_lshl_b32 s20, s24, 3
    s_add_u32 s20, s20, s25
    s_bfe_u32 s14, s2, 0x30003
    s_lshl_b32 s36, s14, 3
    s_and_b32 s25, s2, 6
    s_add_u32 s36, s36, s25
    s_lshr_b32 s25, s2, 7
    s_add_u32 s36, s36, s25
    s_and_b32 s37, s2, 1
    s_lshl_b32 s37, s37, 1
    s_and_b32 s25, s24, 1
    s_add_u32 s37, s37, s25
    s_cmp_ge_u32 s12, 8
    s_cbranch_scc0 L_comp
L_aux:
    s_setprio 3
    s_sub_u32 s40, s12, 8
    s_lshl_b32 s24, s14, 8
    s_lshl_b32 s25, s40, 6
    s_add_u32 s24, s24, s25
    v_lshrrev_b32 v12, 3, v0
    v_add_u32 v13, s24, v12
    v_mul_u32_u24 v13, 1280, v13
    v_and_b32 v14, 7, v0
    v_lshrrev_b32 v15, 4, v0
    v_xor_b32 v15, v14, v15
    v_lshl_add_u32 v4, v15, 4, v13
    v_xor_b32 v15, 4, v15
    v_lshl_add_u32 v5, v15, 4, v13
    v_add_u32 v6, 18432, v4
    v_add_u32 v7, 27648, v5
    v_add_u32 v5, 9216, v5
    s_lshl_b32 s94, s40, 13
    s_lshr_b32 s3, s2, 6
    s_lshl_b32 s3, s3, 2
    s_lshr_b32 s21, 0x0, s3
    s_and_b32 s21, s21, 15
    s_add_u32 s21, s21, s14
    s_and_b32 s3, s2, 7
    s_add_u32 s21, s21, s3
    s_cmp_ge_u32 s21, 10
    s_cselect_b32 s3, 10, 0
    s_sub_u32 s21, s21, s3
    s_cmp_ge_u32 s21, 10
    s_cselect_b32 s3, 10, 0
    s_sub_u32 s21, s21, s3
    s_lshl_b32 s62, s21, 7
    s_lshr_b32 s3, s2, 6
    s_lshl_b32 s24, s14, 2
    s_add_u32 s3, s3, s24
    s_cmp_ge_u32 s40, 2
    s_cbranch_scc1 L_aux_Q
    s_cmp_lt_u32 s20, 27
    s_cbranch_scc0 L_aux_X
    v_and_b32 v15, 2, v12
    s_lshl_b32 s24, s40, 2
    v_xor_b32 v15, v14, v15
    s_lshl_b32 s25, s20, 7
    v_mul_u32_u24 v13, 3456, v12
    v_add_u32 v13, s25, v13
    v_lshl_add_u32 v8, v15, 4, v13
    v_xor_b32 v15, 4, v15
    v_lshl_add_u32 v13, v15, 4, v13
    v_add_u32 v9, 26624, v13
    v_add_u32 v10, 53248, v8
    v_add_u32 v11, 79872, v13
    s_lshl_b32 s95, s40, 12
    s_add_u32 s95, s95, 98304
    s_waitcnt lgkmcnt(0)
    s_mov_b32 s48, s64
    s_mov_b32 s49, s65
    s_mov_b32 s50, 0x280000
    s_mov_b32 s51, 0x00020000
    s_cmp_eq_u32 s40, 0
    s_cselect_b32 s52, s72, s74
    s_cselect_b32 s53, s73, s75
    s_mov_b32 s54, 2211840
    s_mov_b32 s55, 0x00020000
    s_mul_i32 s63, s21, 221184
    s_add_u32 m0, s95, 0
    s_nop 0
    buffer_load_dwordx4 v8, s[52:55], s63 offen lds
    buffer_load_dwordx4 v9, s[52:55], s63 offen offset:1024 lds
    buffer_load_dwordx4 v10, s[52:55], s63 offen offset:2048 lds
    buffer_load_dwordx4 v11, s[52:55], s63 offen offset:3072 lds
    s_add_u32 s63, s63, 110592
    s_cmp_eq_u32 s63, 2211840
    s_cselect_b32 s63, 0, s63
    s_add_u32 m0, s94, 0
    s_nop 0
    buffer_load_dwordx4 v4, s[48:51], s62 offen lds
    buffer_load_dwordx4 v5, s[48:51], s62 offen offset:1024 lds
    buffer_load_dwordx4 v6, s[48:51], s62 offen offset:2048 lds
    buffer_load_dwordx4 v7, s[48:51], s62 offen offset:3072 lds
    s_add_u32 m0, s94, 4096
    s_add_u32 s25, s62, 40960
    buffer_load_dwordx4 v4, s[48:51], s25 offen lds
    buffer_load_dwordx4 v5, s[48:51], s25 offen offset:1024 lds
    buffer_load_dwordx4 v6, s[48:51], s25 offen offset:2048 lds
    buffer_load_dwordx4 v7, s[48:51], s25 offen offset:3072 lds
    s_add_u32 s62, s62, 128
    s_cmp_eq_u32 s62, 1280
    s_cselect_b32 s62, 0, s62
    s_waitcnt vmcnt(10)
    s_add_u32 m0, s95, 12800
    s_nop 0
    buffer_load_dwordx4 v8, s[52:55], s63 offen lds
    buffer_load_dwordx4 v9, s[52:55], s63 offen offset:1024 lds
    buffer_load_dwordx4 v10, s[52:55], s63 offen offset:2048 lds
    buffer_load_dwordx4 v11, s[52:55], s63 offen offset:3072 lds
    s_add_u32 s63, s63, 110592
    s_cmp_eq_u32 s63, 2211840
    s_cselect_b32 s63, 0, s63
    s_lshl_b32 s25, s20, 7
    v_lshl_add_u32 v27, v12, 6, v14
    v_mul_u32_u24 v27, 3456, v27
    s_mul_i32 s24, s14, 27648
    s_add_u32 s24, s24, s25
    v_add_u32 v27, s24, v27
    s_branch L_stF
L_aux_X:
    s_waitcnt lgkmcnt(0)
    s_mov_b32 s48, s64
    s_mov_b32 s49, s65
    s_mov_b32 s50, 0x280000
    s_mov_b32 s51, 0x00020000
    s_add_u32 m0, s94, 0
    s_nop 0
    buffer_load_dwordx4 v4, s[48:51], s62 offen lds
    buffer_load_dwordx4 v5, s[48:51], s62 offen offset:1024 lds
    buffer_load_dwordx4 v6, s[48:51], s62 offen offset:2048 lds
    buffer_load_dwordx4 v7, s[48:51], s62 offen offset:3072 lds
    s_add_u32 m0, s94, 4096
    s_add_u32 s25, s62, 40960
    buffer_load_dwordx4 v4, s[48:51], s25 offen lds
    buffer_load_dwordx4 v5, s[48:51], s25 offen offset:1024 lds
    buffer_load_dwordx4 v6, s[48:51], s25 offen offset:2048 lds
    buffer_load_dwordx4 v7, s[48:51], s25 offen offset:3072 lds
    s_add_u32 s62, s62, 128
    s_cmp_eq_u32 s62, 1280
    s_cselect_b32 s62, 0, s62
    s_branch L_stX
L_aux_Q:
    s_sub_u32 s24, s40, 2
    s_mul_i32 s95, s24, 2304
    s_add_u32 s95, s95, 106496
    s_mul_i32 s24, s24, 144
    s_mul_i32 s25, s13, 40
    v_add_u32 v12, s24, v0
    v_lshrrev_b32 v13, 2, v12
    v_mul_u32_u24 v13, 3840, v13
    v_lshrrev_b32 v14, 4, v12
    v_xor_b32 v14, v14, v12
    v_bfe_u32 v14, v14, 1, 1
    v_mul_u32_u24 v14, 1280, v14
    v_and_b32 v15, 1, v12
    v_lshlrev_b32 v15, 4, v15
    v_add3_u32 v13, v13, v14, v15
    v_cmp_gt_u32 vcc, 128, v12
    v_max_u32 v14, 128, v12
    v_subrev_u32 v14, 128, v14
    v_mul_u32_u24 v15, 13108, v14
    v_lshrrev_b32 v15, 16, v15
    v_mul_u32_u24 v16, 5, v15
    v_sub_u32 v14, v14, v16
    v_mul_u32_u24 v15, 3840, v15
    v_min_u32 v16, 2, v14
    v_mul_u32_u24 v16, 1280, v16
    v_mul_u32_u24 v14, 6, v14
    v_mov_b32 v17, 0x18400820
    v_bfe_u32 v14, v17, v14, 6
    v_add3_u32 v14, v14, v15, v16
    v_cndmask_b32 v13, v14, v13, vcc
    v_add_u32 v8, s25, v13
    v_add_u32 v12, s24, v0
    v_add_u32 v12, 64, v12
    v_lshrrev_b32 v13, 2, v12
    v_mul_u32_u24 v13, 3840, v13
    v_lshrrev_b32 v14, 4, v12
    v_xor_b32 v14, v14, v12
    v_bfe_u32 v14, v14, 1, 1
    v_mul_u32_u24 v14, 1280, v14
    v_and_b32 v15, 1, v12
    v_lshlrev_b32 v15, 4, v15
    v_add3_u32 v13, v13, v14, v15
    v_cmp_gt_u32 vcc, 128, v12
    v_max_u32 v14, 128, v12
    v_subrev_u32 v14, 128, v14
    v_mul_u32_u24 v15, 13108, v14
    v_lshrrev_b32 v15, 16, v15
    v_mul_u32_u24 v16, 5, v15
    v_sub_u32 v14, v14, v16
    v_mul_u32_u24 v15, 3840, v15
    v_min_u32 v16, 2, v14
    v_mul_u32_u24 v16, 1280, v16
    v_mul_u32_u24 v14, 6, v14
    v_mov_b32 v17, 0x18400820
    v_bfe_u32 v14, v17, v14, 6
    v_add3_u32 v14, v14, v15, v16
    v_cndmask_b32 v13, v14, v13, vcc
    v_add_u32 v9, s25, v13
    v_subrev_u32 v9, 1024, v9
    v_add_u32 v12, s24, v0
    v_add_u32 v12, 128, v12
    v_lshrrev_b32 v13, 2, v12
    v_mul_u32_u24 v13, 3840, v13
    v_lshrrev_b32 v14, 4, v12
    v_xor_b32 v14, v14, v12
    v_bfe_u32 v14, v14, 1, 1
    v_mul_u32_u24 v14, 1280, v14
    v_and_b32 v15, 1, v12
    v_lshlrev_b32 v15, 4, v15
    v_add3_u32 v13, v13, v14, v15
    v_cmp_gt_u32 vcc, 128, v12
    v_max_u32 v14, 128, v12
    v_subrev_u32 v14, 128, v14
    v_mul_u32_u24 v15, 13108, v14
    v_lshrrev_b32 v15, 16, v15
    v_mul_u32_u24 v16, 5, v15
    v_sub_u32 v14, v14, v16
    v_mul_u32_u24 v15, 3840, v15
    v_min_u32 v16, 2, v14
    v_mul_u32_u24 v16, 1280, v16
    v_mul_u32_u24 v14, 6, v14
    v_mov_b32 v17, 0x18400820
    v_bfe_u32 v14, v17, v14, 6
    v_add3_u32 v14, v14, v15, v16
    v_cndmask_b32 v13, v14, v13, vcc
    v_add_u32 v10, s25, v13
    s_waitcnt lgkmcnt(0)
    s_mov_b32 s48, s64
    s_mov_b32 s49, s65
    s_mov_b32 s50, 0x280000
    s_mov_b32 s51, 0x00020000
    s_mov_b32 s52, s66
    s_mov_b32 s53, s67
    s_mov_b32 s54, 0x258000
    s_mov_b32 s55, 0x00020000
    s_mul_i32 s63, s21, 245760
    s_add_u32 m0, s95, 0
    s_nop 0
    buffer_load_dwordx4 v8, s[52:55], s63 offen lds
    buffer_load_dwordx4 v9, s[52:55], s63 offen offset:1024 lds
    s_add_u32 m0, s95, 2048
    s_mov_b64 exec, 0xffff
    buffer_load_dwordx4 v10, s[52:55], s63 offen lds
    s_mov_b64 exec, -1
    s_add_u32 s63, s63, 122880
    s_cmp_eq_u32 s63, 2457600
    s_cselect_b32 s63, 0, s63
    s_add_u32 m0, s94, 0
    s_nop 0
    buffer_load_dwordx4 v4, s[48:51], s62 offen lds
    buffer_load_dwordx4 v5, s[48:51], s62 offen offset:1024 lds
    buffer_load_dwordx4 v6, s[48:51], s62 offen offset:2048 lds
    buffer_load_dwordx4 v7, s[48:51], s62 offen offset:3072 lds
    s_add_u32 m0, s94, 4096
    s_add_u32 s25, s62, 40960
    buffer_load_dwordx4 v4, s[48:51], s25 offen lds
    buffer_load_dwordx4 v5, s[48:51], s25 offen offset:1024 lds
    buffer_load_dwordx4 v6, s[48:51], s25 offen offset:2048 lds
    buffer_load_dwordx4 v7, s[48:51], s25 offen offset:3072 lds
    s_add_u32 s62, s62, 128
    s_cmp_eq_u32 s62, 1280
    s_cselect_b32 s62, 0, s62
    s_waitcnt vmcnt(9)
    s_add_u32 m0, s95, 12800
    s_nop 0
    buffer_load_dwordx4 v8, s[52:55], s63 offen lds
    buffer_load_dwordx4 v9, s[52:55], s63 offen offset:1024 lds
    s_add_u32 m0, s95, 14848
    s_mov_b64 exec, 0xffff
    buffer_load_dwordx4 v10, s[52:55], s63 offen lds
    s_mov_b64 exec, -1
    s_add_u32 s63, s63, 122880
    s_cmp_eq_u32 s63, 2457600
    s_cselect_b32 s63, 0, s63
    v_mul_u32_u24 v12, 10923, v0
    v_lshrrev_b32 v12, 16, v12
    v_mul_u32_u24 v13, 6, v12
    v_sub_u32 v13, v0, v13
    v_mul_u32_u24 v27, 245760, v12
    v_lshrrev_b32 v12, 1, v13
    v_mul_u32_u24 v12, 1280, v12
    v_and_b32 v13, 1, v13
    v_lshl_add_u32 v12, v13, 7, v12
    s_lshl_b32 s24, s3, 1
    s_add_u32 s24, s24, s40
    s_sub_u32 s24, s24, 2
    s_mul_i32 s24, s24, 3840
    s_and_b32 s25, s2, 7
    s_mul_i32 s25, s25, 160
    s_add_u32 s24, s24, s25
    v_add3_u32 v27, v27, v12, s24
    s_branch L_stQ
L_stF:
    s_setprio 0
    s_waitcnt vmcnt(4)
    s_barrier
    s_add_u32 m0, s94, 32768
    s_nop 0
    buffer_load_dwordx4 v4, s[48:51], s62 offen lds
    buffer_load_dwordx4 v5, s[48:51], s62 offen offset:1024 lds
    buffer_load_dwordx4 v6, s[48:51], s62 offen offset:2048 lds
    buffer_load_dwordx4 v7, s[48:51], s62 offen offset:3072 lds
    s_add_u32 m0, s94, 36864
    s_add_u32 s25, s62, 40960
    buffer_load_dwordx4 v4, s[48:51], s25 offen lds
    buffer_load_dwordx4 v5, s[48:51], s25 offen offset:1024 lds
    buffer_load_dwordx4 v6, s[48:51], s25 offen offset:2048 lds
    buffer_load_dwordx4 v7, s[48:51], s25 offen offset:3072 lds
    s_add_u32 s62, s62, 128
    s_cmp_eq_u32 s62, 1280
    s_cselect_b32 s62, 0, s62
    s_and_b32 s24, s2, 7
    s_mov_b64 exec, 0xff
    s_add_u32 s25, s24, 8
    s_cmp_ge_u32 s25, 10
    s_cselect_b32 s26, 10, 0
    s_sub_u32 s25, s25, s26
    s_mul_i32 s25, s25, 221184
    buffer_load_dword v28, v27, s[52:55], s25 offen
    s_add_u32 s25, s24, 9
    s_cmp_ge_u32 s25, 10
    s_cselect_b32 s26, 10, 0
    s_sub_u32 s25, s25, s26
    s_mul_i32 s25, s25, 221184
    buffer_load_dword v28, v27, s[52:55], s25 offen
    s_mov_b64 exec, -1
    s_waitcnt vmcnt(10)
    s_barrier
    s_add_u32 m0, s95, 25600
    s_nop 0
    buffer_load_dwordx4 v8, s[52:55], s63 offen lds
    buffer_load_dwordx4 v9, s[52:55], s63 offen offset:1024 lds
    buffer_load_dwordx4 v10, s[52:55], s63 offen offset:2048 lds
    buffer_load_dwordx4 v11, s[52:55], s63 offen offset:3072 lds
    s_add_u32 s63, s63, 110592
    s_cmp_eq_u32 s63, 2211840
    s_cselect_b32 s63, 0, s63
    s_add_u32 m0, s95, 38400
    s_nop 0
    buffer_load_dwordx4 v8, s[52:55], s63 offen lds
    buffer_load_dwordx4 v9, s[52:55], s63 offen offset:1024 lds
    buffer_load_dwordx4 v10, s[52:55], s63 offen offset:2048 lds
    buffer_load_dwordx4 v11, s[52:55], s63 offen offset:3072 lds
    s_add_u32 s63, s63, 110592
    s_cmp_eq_u32 s63, 2211840
    s_cselect_b32 s63, 0, s63
    s_waitcnt vmcnt(4)
    s_barrier
    s_add_u32 m0, s94, 65536
    s_nop 0
    buffer_load_dwordx4 v4, s[48:51], s62 offen lds
    buffer_load_dwordx4 v5, s[48:51], s62 offen offset:1024 lds
    buffer_load_dwordx4 v6, s[48:51], s62 offen offset:2048 lds
    buffer_load_dwordx4 v7, s[48:51], s62 offen offset:3072 lds
    s_add_u32 m0, s94, 69632
    s_add_u32 s25, s62, 40960
    buffer_load_dwordx4 v4, s[48:51], s25 offen lds
    buffer_load_dwordx4 v5, s[48:51], s25 offen offset:1024 lds
    buffer_load_dwordx4 v6, s[48:51], s25 offen offset:2048 lds
    buffer_load_dwordx4 v7, s[48:51], s25 offen offset:3072 lds
    s_add_u32 s62, s62, 128
    s_cmp_eq_u32 s62, 1280
    s_cselect_b32 s62, 0, s62
    s_add_u32 m0, s95, 51200
    s_nop 0
    buffer_load_dwordx4 v8, s[52:55], s63 offen lds
    buffer_load_dwordx4 v9, s[52:55], s63 offen offset:1024 lds
    buffer_load_dwordx4 v10, s[52:55], s63 offen offset:2048 lds
    buffer_load_dwordx4 v11, s[52:55], s63 offen offset:3072 lds
    s_add_u32 s63, s63, 110592
    s_cmp_eq_u32 s63, 2211840
    s_cselect_b32 s63, 0, s63
    s_waitcnt vmcnt(12)
    s_barrier
    s_add_u32 m0, s95, 0
    s_nop 0
    buffer_load_dwordx4 v8, s[52:55], s63 offen lds
    buffer_load_dwordx4 v9, s[52:55], s63 offen offset:1024 lds
    buffer_load_dwordx4 v10, s[52:55], s63 offen offset:2048 lds
    buffer_load_dwordx4 v11, s[52:55], s63 offen offset:3072 lds
    s_add_u32 s63, s63, 110592
    s_cmp_eq_u32 s63, 2211840
    s_cselect_b32 s63, 0, s63
    s_add_u32 m0, s94, 0
    s_nop 0
    buffer_load_dwordx4 v4, s[48:51], s62 offen lds
    buffer_load_dwordx4 v5, s[48:51], s62 offen offset:1024 lds
    buffer_load_dwordx4 v6, s[48:51], s62 offen offset:2048 lds
    buffer_load_dwordx4 v7, s[48:51], s62 offen offset:3072 lds
    s_waitcnt vmcnt(8)
    s_barrier
    s_add_u32 m0, s94, 4096
    s_add_u32 s25, s62, 40960
    buffer_load_dwordx4 v4, s[48:51], s25 offen lds
    buffer_load_dwordx4 v5, s[48:51], s25 offen offset:1024 lds
    buffer_load_dwordx4 v6, s[48:51], s25 offen offset:2048 lds
    buffer_load_dwordx4 v7, s[48:51], s25 offen offset:3072 lds
    s_add_u32 s62, s62, 128
    s_cmp_eq_u32 s62, 1280
    s_cselect_b32 s62, 0, s62
    s_add_u32 m0, s95, 12800
    s_nop 0
    buffer_load_dwordx4 v8, s[52:55], s63 offen lds
    buffer_load_dwordx4 v9, s[52:55], s63 offen offset:1024 lds
    buffer_load_dwordx4 v10, s[52:55], s63 offen offset:2048 lds
    buffer_load_dwordx4 v11, s[52:55], s63 offen offset:3072 lds
    s_add_u32 s63, s63, 110592
    s_cmp_eq_u32 s63, 2211840
    s_cselect_b32 s63, 0, s63
    s_add_u32 m0, s95, 25600
    s_nop 0
    buffer_load_dwordx4 v8, s[52:55], s63 offen lds
    buffer_load_dwordx4 v9, s[52:55], s63 offen offset:1024 lds
    buffer_load_dwordx4 v10, s[52:55], s63 offen offset:2048 lds
    buffer_load_dwordx4 v11, s[52:55], s63 offen offset:3072 lds
    s_add_u32 s63, s63, 110592
    s_cmp_eq_u32 s63, 2211840
    s_cselect_b32 s63, 0, s63
    s_waitcnt vmcnt(16)
    s_barrier
    s_add_u32 m0, s94, 32768
    s_nop 0
    buffer_load_dwordx4 v4, s[48:51], s62 offen lds
    buffer_load_dwordx4 v5, s[48:51], s62 offen offset:1024 lds
    buffer_load_dwordx4 v6, s[48:51], s62 offen offset:2048 lds
    buffer_load_dwordx4 v7, s[48:51], s62 offen offset:3072 lds
    s_add_u32 m0, s94, 36864
    s_add_u32 s25, s62, 40960
    buffer_load_dwordx4 v4, s[48:51], s25 offen lds
    buffer_load_dwordx4 v5, s[48:51], s25 offen offset:1024 lds
    buffer_load_dwordx4 v6, s[48:51], s25 offen offset:2048 lds
    buffer_load_dwordx4 v7, s[48:51], s25 offen offset:3072 lds
    s_add_u32 s62, s62, 128
    s_cmp_eq_u32 s62, 1280
    s_cselect_b32 s62, 0, s62
    s_waitcnt vmcnt(12)
    s_barrier
    s_add_u32 m0, s95, 38400
    s_nop 0
    buffer_load_dwordx4 v8, s[52:55], s63 offen lds
    buffer_load_dwordx4 v9, s[52:55], s63 offen offset:1024 lds
    buffer_load_dwordx4 v10, s[52:55], s63 offen offset:2048 lds
    buffer_load_dwordx4 v11, s[52:55], s63 offen offset:3072 lds
    s_add_u32 s63, s63, 110592
    s_cmp_eq_u32 s63, 2211840
    s_cselect_b32 s63, 0, s63
    s_add_u32 m0, s95, 51200
    s_nop 0
    buffer_load_dwordx4 v8, s[52:55], s63 offen lds
    buffer_load_dwordx4 v9, s[52:55], s63 offen offset:1024 lds
    buffer_load_dwordx4 v10, s[52:55], s63 offen offset:2048 lds
    buffer_load_dwordx4 v11, s[52:55], s63 offen offset:3072 lds
    s_add_u32 s63, s63, 110592
    s_cmp_eq_u32 s63, 2211840
    s_cselect_b32 s63, 0, s63
    s_waitcnt vmcnt(16)
    s_barrier
    s_add_u32 m0, s94, 65536
    s_nop 0
    buffer_load_dwordx4 v4, s[48:51], s62 offen lds
    buffer_load_dwordx4 v5, s[48:51], s62 offen offset:1024 lds
    buffer_load_dwordx4 v6, s[48:51], s62 offen offset:2048 lds
    buffer_load_dwordx4 v7, s[48:51], s62 offen offset:3072 lds
    s_add_u32 m0, s94, 69632
    s_add_u32 s25, s62, 40960
    buffer_load_dwordx4 v4, s[48:51], s25 offen lds
    buffer_load_dwordx4 v5, s[48:51], s25 offen offset:1024 lds
    buffer_load_dwordx4 v6, s[48:51], s25 offen offset:2048 lds
    buffer_load_dwordx4 v7, s[48:51], s25 offen offset:3072 lds
    s_add_u32 s62, s62, 128
    s_cmp_eq_u32 s62, 1280
    s_cselect_b32 s62, 0, s62
    s_waitcnt vmcnt(12)
    s_barrier
    s_add_u32 m0, s95, 0
    s_nop 0
    buffer_load_dwordx4 v8, s[52:55], s63 offen lds
    buffer_load_dwordx4 v9, s[52:55], s63 offen offset:1024 lds
    buffer_load_dwordx4 v10, s[52:55], s63 offen offset:2048 lds
    buffer_load_dwordx4 v11, s[52:55], s63 offen offset:3072 lds
    s_add_u32 s63, s63, 110592
    s_cmp_eq_u32 s63, 2211840
    s_cselect_b32 s63, 0, s63
    s_add_u32 m0, s95, 12800
    s_nop 0
    buffer_load_dwordx4 v8, s[52:55], s63 offen lds
    buffer_load_dwordx4 v9, s[52:55], s63 offen offset:1024 lds
    buffer_load_dwordx4 v10, s[52:55], s63 offen offset:2048 lds
    buffer_load_dwordx4 v11, s[52:55], s63 offen offset:3072 lds
    s_add_u32 s63, s63, 110592
    s_cmp_eq_u32 s63, 2211840
    s_cselect_b32 s63, 0, s63
    s_waitcnt vmcnt(16)
    s_barrier
    s_add_u32 m0, s94, 0
    s_nop 0
    buffer_load_dwordx4 v4, s[48:51], s62 offen lds
    buffer_load_dwordx4 v5, s[48:51], s62 offen offset:1024 lds
    buffer_load_dwordx4 v6, s[48:51], s62 offen offset:2048 lds
    buffer_load_dwordx4 v7, s[48:51], s62 offen offset:3072 lds
    s_add_u32 m0, s94, 4096
    s_add_u32 s25, s62, 40960
    buffer_load_dwordx4 v4, s[48:51], s25 offen lds
    buffer_load_dwordx4 v5, s[48:51], s25 offen offset:1024 lds
    buffer_load_dwordx4 v6, s[48:51], s25 offen offset:2048 lds
    buffer_load_dwordx4 v7, s[48:51], s25 offen offset:3072 lds
    s_add_u32 s62, s62, 128
    s_cmp_eq_u32 s62, 1280
    s_cselect_b32 s62, 0, s62
    s_waitcnt vmcnt(12)
    s_barrier
    s_add_u32 m0, s95, 25600
    s_nop 0
    buffer_load_dwordx4 v8, s[52:55], s63 offen lds
    buffer_load_dwordx4 v9, s[52:55], s63 offen offset:1024 lds
    buffer_load_dwordx4 v10, s[52:55], s63 offen offset:2048 lds
    buffer_load_dwordx4 v11, s[52:55], s63 offen offset:3072 lds
    s_add_u32 s63, s63, 110592
    s_cmp_eq_u32 s63, 2211840
    s_cselect_b32 s63, 0, s63
    s_add_u32 m0, s95, 38400
    s_nop 0
    buffer_load_dwordx4 v8, s[52:55], s63 offen lds
    buffer_load_dwordx4 v9, s[52:55], s63 offen offset:1024 lds
    buffer_load_dwordx4 v10, s[52:55], s63 offen offset:2048 lds
    buffer_load_dwordx4 v11, s[52:55], s63 offen offset:3072 lds
    s_add_u32 s63, s63, 110592
    s_cmp_eq_u32 s63, 2211840
    s_cselect_b32 s63, 0, s63
    s_waitcnt vmcnt(16)
    s_barrier
    s_add_u32 m0, s94, 32768
    s_nop 0
    buffer_load_dwordx4 v4, s[48:51], s62 offen lds
    buffer_load_dwordx4 v5, s[48:51], s62 offen offset:1024 lds
    buffer_load_dwordx4 v6, s[48:51], s62 offen offset:2048 lds
    buffer_load_dwordx4 v7, s[48:51], s62 offen offset:3072 lds
    s_add_u32 m0, s94, 36864
    s_add_u32 s25, s62, 40960
    buffer_load_dwordx4 v4, s[48:51], s25 offen lds
    buffer_load_dwordx4 v5, s[48:51], s25 offen offset:1024 lds
    buffer_load_dwordx4 v6, s[48:51], s25 offen offset:2048 lds
    buffer_load_dwordx4 v7, s[48:51], s25 offen offset:3072 lds
    s_add_u32 s62, s62, 128
    s_cmp_eq_u32 s62, 1280
    s_cselect_b32 s62, 0, s62
    s_waitcnt vmcnt(12)
    s_barrier
    s_add_u32 m0, s95, 51200
    s_nop 0
    buffer_load_dwordx4 v8, s[52:55], s63 offen lds
    buffer_load_dwordx4 v9, s[52:55], s63 offen offset:1024 lds
    buffer_load_dwordx4 v10, s[52:55], s63 offen offset:2048 lds
    buffer_load_dwordx4 v11, s[52:55], s63 offen offset:3072 lds
    s_add_u32 s63, s63, 110592
    s_cmp_eq_u32 s63, 2211840
    s_cselect_b32 s63, 0, s63
    s_add_u32 m0, s95, 0
    s_nop 0
    buffer_load_dwordx4 v8, s[52:55], s63 offen lds
    buffer_load_dwordx4 v9, s[52:55], s63 offen offset:1024 lds
    buffer_load_dwordx4 v10, s[52:55], s63 offen offset:2048 lds
    buffer_load_dwordx4 v11, s[52:55], s63 offen offset:3072 lds
    s_add_u32 s63, s63, 110592
    s_cmp_eq_u32 s63, 2211840
    s_cselect_b32 s63, 0, s63
    s_waitcnt vmcnt(16)
    s_barrier
    s_add_u32 m0, s94, 65536
    s_nop 0
    buffer_load_dwordx4 v4, s[48:51], s62 offen lds
    buffer_load_dwordx4 v5, s[48:51], s62 offen offset:1024 lds
    buffer_load_dwordx4 v6, s[48:51], s62 offen offset:2048 lds
    buffer_load_dwordx4 v7, s[48:51], s62 offen offset:3072 lds
    s_add_u32 m0, s94, 69632
    s_add_u32 s25, s62, 40960
    buffer_load_dwordx4 v4, s[48:51], s25 offen lds
    buffer_load_dwordx4 v5, s[48:51], s25 offen offset:1024 lds
    buffer_load_dwordx4 v6, s[48:51], s25 offen offset:2048 lds
    buffer_load_dwordx4 v7, s[48:51], s25 offen offset:3072 lds
    s_add_u32 s62, s62, 128
    s_cmp_eq_u32 s62, 1280
    s_cselect_b32 s62, 0, s62
    s_waitcnt vmcnt(12)
    s_barrier
    s_add_u32 m0, s95, 12800
    s_nop 0
    buffer_load_dwordx4 v8, s[52:55], s63 offen lds
    buffer_load_dwordx4 v9, s[52:55], s63 offen offset:1024 lds
    buffer_load_dwordx4 v10, s[52:55], s63 offen offset:2048 lds
    buffer_load_dwordx4 v11, s[52:55], s63 offen offset:3072 lds
    s_add_u32 s63, s63, 110592
    s_cmp_eq_u32 s63, 2211840
    s_cselect_b32 s63, 0, s63
    s_add_u32 m0, s95, 25600
    s_nop 0
    buffer_load_dwordx4 v8, s[52:55], s63 offen lds
    buffer_load_dwordx4 v9, s[52:55], s63 offen offset:1024 lds
    buffer_load_dwordx4 v10, s[52:55], s63 offen offset:2048 lds
    buffer_load_dwordx4 v11, s[52:55], s63 offen offset:3072 lds
    s_add_u32 s63, s63, 110592
    s_cmp_eq_u32 s63, 2211840
    s_cselect_b32 s63, 0, s63
    s_waitcnt vmcnt(16)
    s_barrier
    s_add_u32 m0, s94, 0
    s_nop 0
    buffer_load_dwordx4 v4, s[48:51], s62 offen lds
    buffer_load_dwordx4 v5, s[48:51], s62 offen offset:1024 lds
    buffer_load_dwordx4 v6, s[48:51], s62 offen offset:2048 lds
    buffer_load_dwordx4 v7, s[48:51], s62 offen offset:3072 lds
    s_add_u32 m0, s94, 4096
    s_add_u32 s25, s62, 40960
    buffer_load_dwordx4 v4, s[48:51], s25 offen lds
    buffer_load_dwordx4 v5, s[48:51], s25 offen offset:1024 lds
    buffer_load_dwordx4 v6, s[48:51], s25 offen offset:2048 lds
    buffer_load_dwordx4 v7, s[48:51], s25 offen offset:3072 lds
    s_add_u32 s62, s62, 128
    s_cmp_eq_u32 s62, 1280
    s_cselect_b32 s62, 0, s62
    s_waitcnt vmcnt(12)
    s_barrier
    s_mov_b32 s8, s84
    s_mov_b32 s9, s85
    s_mov_b32 s10, 0x2000000
    s_mov_b32 s11, 0x00020000
    v_lshlrev_b32 v1, 4, v0
    v_lshlrev_b32 v18, 2, v0
    v_mov_b32 v20, -1
    v_mov_b32 v21, -1
    v_mov_b32 v22, -1
    v_mov_b32 v23, -1
    s_lshl_b32 s24, s14, 3
    s_lshl_b32 s25, s40, 1
    s_add_u32 s28, s24, s25
    s_mul_i32 s24, s28, 151552
    s_add_u32 s24, s24, 0xa1b000
    s_lshl_b32 s25, s13, 10
    s_add_u32 s88, s24, s25
    s_add_u32 s89, s88, 151552
    s_lshl_b32 s25, s13, 8
    s_add_u32 s24, s24, s25
    s_add_u32 s90, s24, 32768
    s_add_u32 s91, s90, 151552
    s_lshl_b32 s24, s13, 2
    s_add_u32 s24, s24, s40
    s_lshl_b32 s24, s24, 10
    s_add_u32 s47, s24, 0x1a00000
    s_lshl_b32 s24, s14, 7
    s_add_u32 s30, s47, s24
    s_lshl_b32 s24, s14, 2
    s_add_u32 s24, s24, s40
    s_lshl_b32 s24, s24, 5
    s_add_u32 s24, s24, s20
    s_lshl_b32 s24, s24, 7
    s_add_u32 s31, s24, 0x1a20000
    s_add_u32 m0, s95, 38400
    s_nop 0
    buffer_load_dwordx4 v8, s[52:55], s63 offen lds
    buffer_load_dwordx4 v9, s[52:55], s63 offen offset:1024 lds
    buffer_load_dwordx4 v10, s[52:55], s63 offen offset:2048 lds
    buffer_load_dwordx4 v11, s[52:55], s63 offen offset:3072 lds
    s_add_u32 s63, s63, 110592
    s_cmp_eq_u32 s63, 2211840
    s_cselect_b32 s63, 0, s63
    s_add_u32 m0, s95, 51200
    s_nop 0
    buffer_load_dwordx4 v8, s[52:55], s63 offen lds
    buffer_load_dwordx4 v9, s[52:55], s63 offen offset:1024 lds
    buffer_load_dwordx4 v10, s[52:55], s63 offen offset:2048 lds
    buffer_load_dwordx4 v11, s[52:55], s63 offen offset:3072 lds
    s_add_u32 s63, s63, 110592
    s_cmp_eq_u32 s63, 2211840
    s_cselect_b32 s63, 0, s63
    s_waitcnt vmcnt(16)
    s_barrier
    s_waitcnt vmcnt(4)
    s_barrier
    buffer_store_dwordx4 v[20:23], v1, s[8:11], s88 offen sc1
    buffer_store_dwordx4 v[20:23], v1, s[8:11], s89 offen sc1
    buffer_store_dword v20, v18, s[8:11], s90 offen sc1
    buffer_store_dword v20, v18, s[8:11], s91 offen sc1
    s_waitcnt vmcnt(4)
    s_barrier
    s_mov_b32 s56, s82
    s_mov_b32 s57, s83
    s_mov_b32 s58, 0x100
    s_mov_b32 s59, 0x00020000
    v_and_b32 v7, 1, v0
    v_lshlrev_b32 v7, 7, v7
    v_and_b32 v4, 7, v0
    v_lshlrev_b32 v4, 7, v4
    s_mov_b32 s43, 0
L_cntF:
    buffer_load_dword v5, v7, s[56:59], 0 offen sc1
    s_add_u32 s43, s43, 1
    s_waitcnt vmcnt(0)
    v_cmp_eq_u32 vcc, 128, v5
    s_nop 0
    s_cmp_eq_u64 vcc, -1
    s_cbranch_scc1 L_cntF_ok
    s_cmp_lt_u32 s43, 32768
    s_cbranch_scc1 L_cntF
L_cntF_ok:
    buffer_load_dword v30, v4, s[8:11], s47 offen offset:4 sc1
    s_barrier
    s_branch L_aux2
L_stX:
    s_setprio 0
    s_waitcnt vmcnt(0)
    s_barrier
    s_add_u32 m0, s94, 32768
    s_nop 0
    buffer_load_dwordx4 v4, s[48:51], s62 offen lds
    buffer_load_dwordx4 v5, s[48:51], s62 offen offset:1024 lds
    buffer_load_dwordx4 v6, s[48:51], s62 offen offset:2048 lds
    buffer_load_dwordx4 v7, s[48:51], s62 offen offset:3072 lds
    s_add_u32 m0, s94, 36864
    s_add_u32 s25, s62, 40960
    buffer_load_dwordx4 v4, s[48:51], s25 offen lds
    buffer_load_dwordx4 v5, s[48:51], s25 offen offset:1024 lds
    buffer_load_dwordx4 v6, s[48:51], s25 offen offset:2048 lds
    buffer_load_dwordx4 v7, s[48:51], s25 offen offset:3072 lds
    s_add_u32 s62, s62, 128
    s_cmp_eq_u32 s62, 1280
    s_cselect_b32 s62, 0, s62
    s_barrier
    s_waitcnt vmcnt(0)
    s_barrier
    s_add_u32 m0, s94, 65536
    s_nop 0
    buffer_load_dwordx4 v4, s[48:51], s62 offen lds
    buffer_load_dwordx4 v5, s[48:51], s62 offen offset:1024 lds
    buffer_load_dwordx4 v6, s[48:51], s62 offen offset:2048 lds
    buffer_load_dwordx4 v7, s[48:51], s62 offen offset:3072 lds
    s_add_u32 m0, s94, 69632
    s_add_u32 s25, s62, 40960
    buffer_load_dwordx4 v4, s[48:51], s25 offen lds
    buffer_load_dwordx4 v5, s[48:51], s25 offen offset:1024 lds
    buffer_load_dwordx4 v6, s[48:51], s25 offen offset:2048 lds
    buffer_load_dwordx4 v7, s[48:51], s25 offen offset:3072 lds
    s_add_u32 s62, s62, 128
    s_cmp_eq_u32 s62, 1280
    s_cselect_b32 s62, 0, s62
    s_barrier
    s_add_u32 m0, s94, 0
    s_nop 0
    buffer_load_dwordx4 v4, s[48:51], s62 offen lds
    buffer_load_dwordx4 v5, s[48:51], s62 offen offset:1024 lds
    buffer_load_dwordx4 v6, s[48:51], s62 offen offset:2048 lds
    buffer_load_dwordx4 v7, s[48:51], s62 offen offset:3072 lds
    s_waitcnt vmcnt(4)
    s_barrier
    s_add_u32 m0, s94, 4096
    s_add_u32 s25, s62, 40960
    buffer_load_dwordx4 v4, s[48:51], s25 offen lds
    buffer_load_dwordx4 v5, s[48:51], s25 offen offset:1024 lds
    buffer_load_dwordx4 v6, s[48:51], s25 offen offset:2048 lds
    buffer_load_dwordx4 v7, s[48:51], s25 offen offset:3072 lds
    s_add_u32 s62, s62, 128
    s_cmp_eq_u32 s62, 1280
    s_cselect_b32 s62, 0, s62
    s_barrier
    s_add_u32 m0, s94, 32768
    s_nop 0
    buffer_load_dwordx4 v4, s[48:51], s62 offen lds
    buffer_load_dwordx4 v5, s[48:51], s62 offen offset:1024 lds
    buffer_load_dwordx4 v6, s[48:51], s62 offen offset:2048 lds
    buffer_load_dwordx4 v7, s[48:51], s62 offen offset:3072 lds
    s_add_u32 m0, s94, 36864
    s_add_u32 s25, s62, 40960
    buffer_load_dwordx4 v4, s[48:51], s25 offen lds
    buffer_load_dwordx4 v5, s[48:51], s25 offen offset:1024 lds
    buffer_load_dwordx4 v6, s[48:51], s25 offen offset:2048 lds
    buffer_load_dwordx4 v7, s[48:51], s25 offen offset:3072 lds
    s_add_u32 s62, s62, 128
    s_cmp_eq_u32 s62, 1280
    s_cselect_b32 s62, 0, s62
    s_waitcnt vmcnt(8)
    s_barrier
    s_barrier
    s_add_u32 m0, s94, 65536
    s_nop 0
    buffer_load_dwordx4 v4, s[48:51], s62 offen lds
    buffer_load_dwordx4 v5, s[48:51], s62 offen offset:1024 lds
    buffer_load_dwordx4 v6, s[48:51], s62 offen offset:2048 lds
    buffer_load_dwordx4 v7, s[48:51], s62 offen offset:3072 lds
    s_add_u32 m0, s94, 69632
    s_add_u32 s25, s62, 40960
    buffer_load_dwordx4 v4, s[48:51], s25 offen lds
    buffer_load_dwordx4 v5, s[48:51], s25 offen offset:1024 lds
    buffer_load_dwordx4 v6, s[48:51], s25 offen offset:2048 lds
    buffer_load_dwordx4 v7, s[48:51], s25 offen offset:3072 lds
    s_add_u32 s62, s62, 128
    s_cmp_eq_u32 s62, 1280
    s_cselect_b32 s62, 0, s62
    s_waitcnt vmcnt(8)
    s_barrier
    s_barrier
    s_add_u32 m0, s94, 0
    s_nop 0
    buffer_load_dwordx4 v4, s[48:51], s62 offen lds
    buffer_load_dwordx4 v5, s[48:51], s62 offen offset:1024 lds
    buffer_load_dwordx4 v6, s[48:51], s62 offen offset:2048 lds
    buffer_load_dwordx4 v7, s[48:51], s62 offen offset:3072 lds
    s_add_u32 m0, s94, 4096
    s_add_u32 s25, s62, 40960
    buffer_load_dwordx4 v4, s[48:51], s25 offen lds
    buffer_load_dwordx4 v5, s[48:51], s25 offen offset:1024 lds
    buffer_load_dwordx4 v6, s[48:51], s25 offen offset:2048 lds
    buffer_load_dwordx4 v7, s[48:51], s25 offen offset:3072 lds
    s_add_u32 s62, s62, 128
    s_cmp_eq_u32 s62, 1280
    s_cselect_b32 s62, 0, s62
    s_waitcnt vmcnt(8)
    s_barrier
    s_barrier
    s_add_u32 m0, s94, 32768
    s_nop 0
    buffer_load_dwordx4 v4, s[48:51], s62 offen lds
    buffer_load_dwordx4 v5, s[48:51], s62 offen offset:1024 lds
    buffer_load_dwordx4 v6, s[48:51], s62 offen offset:2048 lds
    buffer_load_dwordx4 v7, s[48:51], s62 offen offset:3072 lds
    s_add_u32 m0, s94, 36864
    s_add_u32 s25, s62, 40960
    buffer_load_dwordx4 v4, s[48:51], s25 offen lds
    buffer_load_dwordx4 v5, s[48:51], s25 offen offset:1024 lds
    buffer_load_dwordx4 v6, s[48:51], s25 offen offset:2048 lds
    buffer_load_dwordx4 v7, s[48:51], s25 offen offset:3072 lds
    s_add_u32 s62, s62, 128
    s_cmp_eq_u32 s62, 1280
    s_cselect_b32 s62, 0, s62
    s_waitcnt vmcnt(8)
    s_barrier
    s_barrier
    s_add_u32 m0, s94, 65536
    s_nop 0
    buffer_load_dwordx4 v4, s[48:51], s62 offen lds
    buffer_load_dwordx4 v5, s[48:51], s62 offen offset:1024 lds
    buffer_load_dwordx4 v6, s[48:51], s62 offen offset:2048 lds
    buffer_load_dwordx4 v7, s[48:51], s62 offen offset:3072 lds
    s_add_u32 m0, s94, 69632
    s_add_u32 s25, s62, 40960
    buffer_load_dwordx4 v4, s[48:51], s25 offen lds
    buffer_load_dwordx4 v5, s[48:51], s25 offen offset:1024 lds
    buffer_load_dwordx4 v6, s[48:51], s25 offen offset:2048 lds
    buffer_load_dwordx4 v7, s[48:51], s25 offen offset:3072 lds
    s_add_u32 s62, s62, 128
    s_cmp_eq_u32 s62, 1280
    s_cselect_b32 s62, 0, s62
    s_waitcnt vmcnt(8)
    s_barrier
    s_barrier
    s_add_u32 m0, s94, 0
    s_nop 0
    buffer_load_dwordx4 v4, s[48:51], s62 offen lds
    buffer_load_dwordx4 v5, s[48:51], s62 offen offset:1024 lds
    buffer_load_dwordx4 v6, s[48:51], s62 offen offset:2048 lds
    buffer_load_dwordx4 v7, s[48:51], s62 offen offset:3072 lds
    s_add_u32 m0, s94, 4096
    s_add_u32 s25, s62, 40960
    buffer_load_dwordx4 v4, s[48:51], s25 offen lds
    buffer_load_dwordx4 v5, s[48:51], s25 offen offset:1024 lds
    buffer_load_dwordx4 v6, s[48:51], s25 offen offset:2048 lds
    buffer_load_dwordx4 v7, s[48:51], s25 offen offset:3072 lds
    s_add_u32 s62, s62, 128
    s_cmp_eq_u32 s62, 1280
    s_cselect_b32 s62, 0, s62
    s_waitcnt vmcnt(8)
    s_barrier
    s_mov_b32 s8, s84
    s_mov_b32 s9, s85
    s_mov_b32 s10, 0x2000000
    s_mov_b32 s11, 0x00020000
    v_lshlrev_b32 v1, 4, v0
    v_lshlrev_b32 v18, 2, v0
    v_mov_b32 v20, -1
    v_mov_b32 v21, -1
    v_mov_b32 v22, -1
    v_mov_b32 v23, -1
    s_lshl_b32 s24, s14, 3
    s_lshl_b32 s25, s40, 1
    s_add_u32 s28, s24, s25
    s_mul_i32 s24, s28, 151552
    s_add_u32 s24, s24, 0xa1b000
    s_lshl_b32 s25, s13, 10
    s_add_u32 s88, s24, s25
    s_add_u32 s89, s88, 151552
    s_lshl_b32 s25, s13, 8
    s_add_u32 s24, s24, s25
    s_add_u32 s90, s24, 32768
    s_add_u32 s91, s90, 151552
    s_lshl_b32 s24, s13, 2
    s_add_u32 s24, s24, s40
    s_lshl_b32 s24, s24, 10
    s_add_u32 s47, s24, 0x1a00000
    s_lshl_b32 s24, s14, 7
    s_add_u32 s30, s47, s24
    s_lshl_b32 s24, s14, 2
    s_add_u32 s24, s24, s40
    s_lshl_b32 s24, s24, 5
    s_add_u32 s24, s24, s20
    s_lshl_b32 s24, s24, 7
    s_add_u32 s31, s24, 0x1a20000
    s_barrier
    s_waitcnt vmcnt(0)
    s_barrier
    buffer_store_dwordx4 v[20:23], v1, s[8:11], s88 offen sc1
    buffer_store_dwordx4 v[20:23], v1, s[8:11], s89 offen sc1
    buffer_store_dword v20, v18, s[8:11], s90 offen sc1
    buffer_store_dword v20, v18, s[8:11], s91 offen sc1
    s_barrier
    s_mov_b32 s56, s82
    s_mov_b32 s57, s83
    s_mov_b32 s58, 0x100
    s_mov_b32 s59, 0x00020000
    v_and_b32 v7, 1, v0
    v_lshlrev_b32 v7, 7, v7
    v_and_b32 v4, 7, v0
    v_lshlrev_b32 v4, 7, v4
    s_mov_b32 s43, 0
L_cntX:
    buffer_load_dword v5, v7, s[56:59], 0 offen sc1
    s_add_u32 s43, s43, 1
    s_waitcnt vmcnt(0)
    v_cmp_eq_u32 vcc, 128, v5
    s_nop 0
    s_cmp_eq_u64 vcc, -1
    s_cbranch_scc1 L_cntX_ok
    s_cmp_lt_u32 s43, 32768
    s_cbranch_scc1 L_cntX
L_cntX_ok:
    buffer_load_dword v30, v4, s[8:11], s47 offen offset:4 sc1
    s_barrier
    s_branch L_aux2
L_stQ:
    s_setprio 0
    s_waitcnt vmcnt(3)
    s_barrier
    s_add_u32 m0, s94, 32768
    s_nop 0
    buffer_load_dwordx4 v4, s[48:51], s62 offen lds
    buffer_load_dwordx4 v5, s[48:51], s62 offen offset:1024 lds
    buffer_load_dwordx4 v6, s[48:51], s62 offen offset:2048 lds
    buffer_load_dwordx4 v7, s[48:51], s62 offen offset:3072 lds
    s_add_u32 m0, s94, 36864
    s_add_u32 s25, s62, 40960
    buffer_load_dwordx4 v4, s[48:51], s25 offen lds
    buffer_load_dwordx4 v5, s[48:51], s25 offen offset:1024 lds
    buffer_load_dwordx4 v6, s[48:51], s25 offen offset:2048 lds
    buffer_load_dwordx4 v7, s[48:51], s25 offen offset:3072 lds
    s_add_u32 s62, s62, 128
    s_cmp_eq_u32 s62, 1280
    s_cselect_b32 s62, 0, s62
    s_and_b32 s24, s2, 7
    s_mov_b64 exec, 0x3f
    s_add_u32 s25, s24, 8
    s_cmp_ge_u32 s25, 10
    s_cselect_b32 s26, 10, 0
    s_sub_u32 s25, s25, s26
    s_mul_i32 s25, s25, 245760
    buffer_load_dword v28, v27, s[52:55], s25 offen
    s_add_u32 s25, s24, 9
    s_cmp_ge_u32 s25, 10
    s_cselect_b32 s26, 10, 0
    s_sub_u32 s25, s25, s26
    s_mul_i32 s25, s25, 245760
    buffer_load_dword v28, v27, s[52:55], s25 offen
    s_mov_b64 exec, -1
    s_waitcnt vmcnt(10)
    s_barrier
    s_add_u32 m0, s95, 25600
    s_nop 0
    buffer_load_dwordx4 v8, s[52:55], s63 offen lds
    buffer_load_dwordx4 v9, s[52:55], s63 offen offset:1024 lds
    s_add_u32 m0, s95, 27648
    s_mov_b64 exec, 0xffff
    buffer_load_dwordx4 v10, s[52:55], s63 offen lds
    s_mov_b64 exec, -1
    s_add_u32 s63, s63, 122880
    s_cmp_eq_u32 s63, 2457600
    s_cselect_b32 s63, 0, s63
    s_add_u32 m0, s95, 38400
    s_nop 0
    buffer_load_dwordx4 v8, s[52:55], s63 offen lds
    buffer_load_dwordx4 v9, s[52:55], s63 offen offset:1024 lds
    s_add_u32 m0, s95, 40448
    s_mov_b64 exec, 0xffff
    buffer_load_dwordx4 v10, s[52:55], s63 offen lds
    s_mov_b64 exec, -1
    s_add_u32 s63, s63, 122880
    s_cmp_eq_u32 s63, 2457600
    s_cselect_b32 s63, 0, s63
    s_waitcnt vmcnt(3)
    s_barrier
    s_add_u32 m0, s94, 65536
    s_nop 0
    buffer_load_dwordx4 v4, s[48:51], s62 offen lds
    buffer_load_dwordx4 v5, s[48:51], s62 offen offset:1024 lds
    buffer_load_dwordx4 v6, s[48:51], s62 offen offset:2048 lds
    buffer_load_dwordx4 v7, s[48:51], s62 offen offset:3072 lds
    s_add_u32 m0, s94, 69632
    s_add_u32 s25, s62, 40960
    buffer_load_dwordx4 v4, s[48:51], s25 offen lds
    buffer_load_dwordx4 v5, s[48:51], s25 offen offset:1024 lds
    buffer_load_dwordx4 v6, s[48:51], s25 offen offset:2048 lds
    buffer_load_dwordx4 v7, s[48:51], s25 offen offset:3072 lds
    s_add_u32 s62, s62, 128
    s_cmp_eq_u32 s62, 1280
    s_cselect_b32 s62, 0, s62
    s_add_u32 m0, s95, 51200
    s_nop 0
    buffer_load_dwordx4 v8, s[52:55], s63 offen lds
    buffer_load_dwordx4 v9, s[52:55], s63 offen offset:1024 lds
    s_add_u32 m0, s95, 53248
    s_mov_b64 exec, 0xffff
    buffer_load_dwordx4 v10, s[52:55], s63 offen lds
    s_mov_b64 exec, -1
    s_add_u32 s63, s63, 122880
    s_cmp_eq_u32 s63, 2457600
    s_cselect_b32 s63, 0, s63
    s_waitcnt vmcnt(11)
    s_barrier
    s_add_u32 m0, s95, 0
    s_nop 0
    buffer_load_dwordx4 v8, s[52:55], s63 offen lds
    buffer_load_dwordx4 v9, s[52:55], s63 offen offset:1024 lds
    s_add_u32 m0, s95, 2048
    s_mov_b64 exec, 0xffff
    buffer_load_dwordx4 v10, s[52:55], s63 offen lds
    s_mov_b64 exec, -1
    s_add_u32 s63, s63, 122880
    s_cmp_eq_u32 s63, 2457600
    s_cselect_b32 s63, 0, s63
    s_add_u32 m0, s94, 0
    s_nop 0
    buffer_load_dwordx4 v4, s[48:51], s62 offen lds
    buffer_load_dwordx4 v5, s[48:51], s62 offen offset:1024 lds
    buffer_load_dwordx4 v6, s[48:51], s62 offen offset:2048 lds
    buffer_load_dwordx4 v7, s[48:51], s62 offen offset:3072 lds
    s_waitcnt vmcnt(7)
    s_barrier
    s_add_u32 m0, s94, 4096
    s_add_u32 s25, s62, 40960
    buffer_load_dwordx4 v4, s[48:51], s25 offen lds
    buffer_load_dwordx4 v5, s[48:51], s25 offen offset:1024 lds
    buffer_load_dwordx4 v6, s[48:51], s25 offen offset:2048 lds
    buffer_load_dwordx4 v7, s[48:51], s25 offen offset:3072 lds
    s_add_u32 s62, s62, 128
    s_cmp_eq_u32 s62, 1280
    s_cselect_b32 s62, 0, s62
    s_add_u32 m0, s95, 12800
    s_nop 0
    buffer_load_dwordx4 v8, s[52:55], s63 offen lds
    buffer_load_dwordx4 v9, s[52:55], s63 offen offset:1024 lds
    s_add_u32 m0, s95, 14848
    s_mov_b64 exec, 0xffff
    buffer_load_dwordx4 v10, s[52:55], s63 offen lds
    s_mov_b64 exec, -1
    s_add_u32 s63, s63, 122880
    s_cmp_eq_u32 s63, 2457600
    s_cselect_b32 s63, 0, s63
    s_add_u32 m0, s95, 25600
    s_nop 0
    buffer_load_dwordx4 v8, s[52:55], s63 offen lds
    buffer_load_dwordx4 v9, s[52:55], s63 offen offset:1024 lds
    s_add_u32 m0, s95, 27648
    s_mov_b64 exec, 0xffff
    buffer_load_dwordx4 v10, s[52:55], s63 offen lds
    s_mov_b64 exec, -1
    s_add_u32 s63, s63, 122880
    s_cmp_eq_u32 s63, 2457600
    s_cselect_b32 s63, 0, s63
    s_waitcnt vmcnt(14)
    s_barrier
    s_cmp_eq_u32 s40, 3
    s_cbranch_scc0 L_zb13
    s_mov_b32 s8, s84
    s_mov_b32 s9, s85
    s_mov_b32 s10, 0x2000000
    s_mov_b32 s11, 0x00020000
    s_sub_u32 s29, s20, 27
    s_lshl_b32 s29, s29, 3
    s_add_u32 s29, s29, s14
    s_lshl_b32 s24, s13, 12
    s_lshl_b32 s25, s14, 7
    s_add_u32 s24, s24, s25
    s_lshl_b32 s25, s14, 14
    s_lshl_b32 s26, s20, 7
    s_add_u32 s25, s25, s26
    s_add_u32 s25, s25, 114688
    s_lshl_b32 s26, s29, 7
    s_add_u32 s26, s26, 196608
    s_cmp_lt_u32 s20, 27
    s_cselect_b32 s26, 0x40000000, s26
    v_lshl_add_u32 v14, v0, 10, s24
    v_lshl_add_u32 v15, v0, 12, s25
    v_cmp_gt_u32 vcc, 4, v0
    v_lshl_add_u32 v16, v0, 13, s26
    v_cndmask_b32 v14, v15, v14, vcc
    v_cmp_gt_u32 vcc, 8, v0
    s_mov_b32 s24, 0x1a00000
    v_cndmask_b32 v14, v16, v14, vcc
    s_getreg_b32 s3, hwreg(HW_REG_XCC_ID, 0, 4)
    v_mov_b32 v18, 0
    v_mov_b32 v19, s3
    s_mov_b64 exec, 0xfff
    buffer_store_dwordx2 v[18:19], v14, s[8:11], s24 offen sc1
    s_mov_b64 exec, -1
L_zb13:
    s_add_u32 m0, s94, 32768
    s_nop 0
    buffer_load_dwordx4 v4, s[48:51], s62 offen lds
    buffer_load_dwordx4 v5, s[48:51], s62 offen offset:1024 lds
    buffer_load_dwordx4 v6, s[48:51], s62 offen offset:2048 lds
    buffer_load_dwordx4 v7, s[48:51], s62 offen offset:3072 lds
    s_add_u32 m0, s94, 36864
    s_add_u32 s25, s62, 40960
    buffer_load_dwordx4 v4, s[48:51], s25 offen lds
    buffer_load_dwordx4 v5, s[48:51], s25 offen offset:1024 lds
    buffer_load_dwordx4 v6, s[48:51], s25 offen offset:2048 lds
    buffer_load_dwordx4 v7, s[48:51], s25 offen offset:3072 lds
    s_add_u32 s62, s62, 128
    s_cmp_eq_u32 s62, 1280
    s_cselect_b32 s62, 0, s62
    s_waitcnt vmcnt(11)
    s_barrier
    s_add_u32 m0, s95, 38400
    s_nop 0
    buffer_load_dwordx4 v8, s[52:55], s63 offen lds
    buffer_load_dwordx4 v9, s[52:55], s63 offen offset:1024 lds
    s_add_u32 m0, s95, 40448
    s_mov_b64 exec, 0xffff
    buffer_load_dwordx4 v10, s[52:55], s63 offen lds
    s_mov_b64 exec, -1
    s_add_u32 s63, s63, 122880
    s_cmp_eq_u32 s63, 2457600
    s_cselect_b32 s63, 0, s63
    s_add_u32 m0, s95, 51200
    s_nop 0
    buffer_load_dwordx4 v8, s[52:55], s63 offen lds
    buffer_load_dwordx4 v9, s[52:55], s63 offen offset:1024 lds
    s_add_u32 m0, s95, 53248
    s_mov_b64 exec, 0xffff
    buffer_load_dwordx4 v10, s[52:55], s63 offen lds
    s_mov_b64 exec, -1
    s_add_u32 s63, s63, 122880
    s_cmp_eq_u32 s63, 2457600
    s_cselect_b32 s63, 0, s63
    s_waitcnt vmcnt(14)
    s_barrier
    s_add_u32 m0, s94, 65536
    s_nop 0
    buffer_load_dwordx4 v4, s[48:51], s62 offen lds
    buffer_load_dwordx4 v5, s[48:51], s62 offen offset:1024 lds
    buffer_load_dwordx4 v6, s[48:51], s62 offen offset:2048 lds
    buffer_load_dwordx4 v7, s[48:51], s62 offen offset:3072 lds
    s_add_u32 m0, s94, 69632
    s_add_u32 s25, s62, 40960
    buffer_load_dwordx4 v4, s[48:51], s25 offen lds
    buffer_load_dwordx4 v5, s[48:51], s25 offen offset:1024 lds
    buffer_load_dwordx4 v6, s[48:51], s25 offen offset:2048 lds
    buffer_load_dwordx4 v7, s[48:51], s25 offen offset:3072 lds
    s_add_u32 s62, s62, 128
    s_cmp_eq_u32 s62, 1280
    s_cselect_b32 s62, 0, s62
    s_waitcnt vmcnt(11)
    s_barrier
    s_add_u32 m0, s95, 0
    s_nop 0
    buffer_load_dwordx4 v8, s[52:55], s63 offen lds
    buffer_load_dwordx4 v9, s[52:55], s63 offen offset:1024 lds
    s_add_u32 m0, s95, 2048
    s_mov_b64 exec, 0xffff
    buffer_load_dwordx4 v10, s[52:55], s63 offen lds
    s_mov_b64 exec, -1
    s_add_u32 s63, s63, 122880
    s_cmp_eq_u32 s63, 2457600
    s_cselect_b32 s63, 0, s63
    s_add_u32 m0, s95, 12800
    s_nop 0
    buffer_load_dwordx4 v8, s[52:55], s63 offen lds
    buffer_load_dwordx4 v9, s[52:55], s63 offen offset:1024 lds
    s_add_u32 m0, s95, 14848
    s_mov_b64 exec, 0xffff
    buffer_load_dwordx4 v10, s[52:55], s63 offen lds
    s_mov_b64 exec, -1
    s_add_u32 s63, s63, 122880
    s_cmp_eq_u32 s63, 2457600
    s_cselect_b32 s63, 0, s63
    s_waitcnt vmcnt(14)
    s_barrier
    s_cmp_eq_u32 s40, 3
    s_cbranch_scc0 L_zb17
    s_mov_b32 s56, s82
    s_mov_b32 s57, s83
    s_mov_b32 s58, 0x100
    s_mov_b32 s59, 0x00020000
    s_and_b32 s3, s2, 1
    s_lshl_b32 s3, s3, 7
    v_mov_b32 v14, 1
    v_mov_b32 v13, 0
    s_mov_b64 exec, 1
    buffer_atomic_add v14, v13, s[56:59], s3 offen sc1
    s_mov_b64 exec, -1
L_zb17:
    s_add_u32 m0, s94, 0
    s_nop 0
    buffer_load_dwordx4 v4, s[48:51], s62 offen lds
    buffer_load_dwordx4 v5, s[48:51], s62 offen offset:1024 lds
    buffer_load_dwordx4 v6, s[48:51], s62 offen offset:2048 lds
    buffer_load_dwordx4 v7, s[48:51], s62 offen offset:3072 lds
    s_add_u32 m0, s94, 4096
    s_add_u32 s25, s62, 40960
    buffer_load_dwordx4 v4, s[48:51], s25 offen lds
    buffer_load_dwordx4 v5, s[48:51], s25 offen offset:1024 lds
    buffer_load_dwordx4 v6, s[48:51], s25 offen offset:2048 lds
    buffer_load_dwordx4 v7, s[48:51], s25 offen offset:3072 lds
    s_add_u32 s62, s62, 128
    s_cmp_eq_u32 s62, 1280
    s_cselect_b32 s62, 0, s62
    s_waitcnt vmcnt(11)
    s_barrier
    s_add_u32 m0, s95, 25600
    s_nop 0
    buffer_load_dwordx4 v8, s[52:55], s63 offen lds
    buffer_load_dwordx4 v9, s[52:55], s63 offen offset:1024 lds
    s_add_u32 m0, s95, 27648
    s_mov_b64 exec, 0xffff
    buffer_load_dwordx4 v10, s[52:55], s63 offen lds
    s_mov_b64 exec, -1
    s_add_u32 s63, s63, 122880
    s_cmp_eq_u32 s63, 2457600
    s_cselect_b32 s63, 0, s63
    s_add_u32 m0, s95, 38400
    s_nop 0
    buffer_load_dwordx4 v8, s[52:55], s63 offen lds
    buffer_load_dwordx4 v9, s[52:55], s63 offen offset:1024 lds
    s_add_u32 m0, s95, 40448
    s_mov_b64 exec, 0xffff
    buffer_load_dwordx4 v10, s[52:55], s63 offen lds
    s_mov_b64 exec, -1
    s_add_u32 s63, s63, 122880
    s_cmp_eq_u32 s63, 2457600
    s_cselect_b32 s63, 0, s63
    s_waitcnt vmcnt(14)
    s_barrier
    s_add_u32 m0, s94, 32768
    s_nop 0
    buffer_load_dwordx4 v4, s[48:51], s62 offen lds
    buffer_load_dwordx4 v5, s[48:51], s62 offen offset:1024 lds
    buffer_load_dwordx4 v6, s[48:51], s62 offen offset:2048 lds
    buffer_load_dwordx4 v7, s[48:51], s62 offen offset:3072 lds
    s_add_u32 m0, s94, 36864
    s_add_u32 s25, s62, 40960
    buffer_load_dwordx4 v4, s[48:51], s25 offen lds
    buffer_load_dwordx4 v5, s[48:51], s25 offen offset:1024 lds
    buffer_load_dwordx4 v6, s[48:51], s25 offen offset:2048 lds
    buffer_load_dwordx4 v7, s[48:51], s25 offen offset:3072 lds
    s_add_u32 s62, s62, 128
    s_cmp_eq_u32 s62, 1280
    s_cselect_b32 s62, 0, s62
    s_waitcnt vmcnt(11)
    s_barrier
    s_add_u32 m0, s95, 51200
    s_nop 0
    buffer_load_dwordx4 v8, s[52:55], s63 offen lds
    buffer_load_dwordx4 v9, s[52:55], s63 offen offset:1024 lds
    s_add_u32 m0, s95, 53248
    s_mov_b64 exec, 0xffff
    buffer_load_dwordx4 v10, s[52:55], s63 offen lds
    s_mov_b64 exec, -1
    s_add_u32 s63, s63, 122880
    s_cmp_eq_u32 s63, 2457600
    s_cselect_b32 s63, 0, s63
    s_add_u32 m0, s95, 0
    s_nop 0
    buffer_load_dwordx4 v8, s[52:55], s63 offen lds
    buffer_load_dwordx4 v9, s[52:55], s63 offen offset:1024 lds
    s_add_u32 m0, s95, 2048
    s_mov_b64 exec, 0xffff
    buffer_load_dwordx4 v10, s[52:55], s63 offen lds
    s_mov_b64 exec, -1
    s_add_u32 s63, s63, 122880
    s_cmp_eq_u32 s63, 2457600
    s_cselect_b32 s63, 0, s63
    s_waitcnt vmcnt(14)
    s_barrier
    s_add_u32 m0, s94, 65536
    s_nop 0
    buffer_load_dwordx4 v4, s[48:51], s62 offen lds
    buffer_load_dwordx4 v5, s[48:51], s62 offen offset:1024 lds
    buffer_load_dwordx4 v6, s[48:51], s62 offen offset:2048 lds
    buffer_load_dwordx4 v7, s[48:51], s62 offen offset:3072 lds
    s_add_u32 m0, s94, 69632
    s_add_u32 s25, s62, 40960
    buffer_load_dwordx4 v4, s[48:51], s25 offen lds
    buffer_load_dwordx4 v5, s[48:51], s25 offen offset:1024 lds
    buffer_load_dwordx4 v6, s[48:51], s25 offen offset:2048 lds
    buffer_load_dwordx4 v7, s[48:51], s25 offen offset:3072 lds
    s_add_u32 s62, s62, 128
    s_cmp_eq_u32 s62, 1280
    s_cselect_b32 s62, 0, s62
    s_waitcnt vmcnt(11)
    s_barrier
    s_add_u32 m0, s95, 12800
    s_nop 0
    buffer_load_dwordx4 v8, s[52:55], s63 offen lds
    buffer_load_dwordx4 v9, s[52:55], s63 offen offset:1024 lds
    s_add_u32 m0, s95, 14848
    s_mov_b64 exec, 0xffff
    buffer_load_dwordx4 v10, s[52:55], s63 offen lds
    s_mov_b64 exec, -1
    s_add_u32 s63, s63, 122880
    s_cmp_eq_u32 s63, 2457600
    s_cselect_b32 s63, 0, s63
    s_add_u32 m0, s95, 25600
    s_nop 0
    buffer_load_dwordx4 v8, s[52:55], s63 offen lds
    buffer_load_dwordx4 v9, s[52:55], s63 offen offset:1024 lds
    s_add_u32 m0, s95, 27648
    s_mov_b64 exec, 0xffff
    buffer_load_dwordx4 v10, s[52:55], s63 offen lds
    s_mov_b64 exec, -1
    s_add_u32 s63, s63, 122880
    s_cmp_eq_u32 s63, 2457600
    s_cselect_b32 s63, 0, s63
    s_waitcnt vmcnt(14)
    s_barrier
    s_add_u32 m0, s94, 0
    s_nop 0
    buffer_load_dwordx4 v4, s[48:51], s62 offen lds
    buffer_load_dwordx4 v5, s[48:51], s62 offen offset:1024 lds
    buffer_load_dwordx4 v6, s[48:51], s62 offen offset:2048 lds
    buffer_load_dwordx4 v7, s[48:51], s62 offen offset:3072 lds
    s_add_u32 m0, s94, 4096
    s_add_u32 s25, s62, 40960
    buffer_load_dwordx4 v4, s[48:51], s25 offen lds
    buffer_load_dwordx4 v5, s[48:51], s25 offen offset:1024 lds
    buffer_load_dwordx4 v6, s[48:51], s25 offen offset:2048 lds
    buffer_load_dwordx4 v7, s[48:51], s25 offen offset:3072 lds
    s_add_u32 s62, s62, 128
    s_cmp_eq_u32 s62, 1280
    s_cselect_b32 s62, 0, s62
    s_waitcnt vmcnt(11)
    s_barrier
    s_mov_b32 s8, s84
    s_mov_b32 s9, s85
    s_mov_b32 s10, 0x2000000
    s_mov_b32 s11, 0x00020000
    v_lshlrev_b32 v1, 4, v0
    v_lshlrev_b32 v18, 2, v0
    v_mov_b32 v20, -1
    v_mov_b32 v21, -1
    v_mov_b32 v22, -1
    v_mov_b32 v23, -1
    s_lshl_b32 s24, s14, 3
    s_lshl_b32 s25, s40, 1
    s_add_u32 s28, s24, s25
    s_mul_i32 s24, s28, 151552
    s_add_u32 s24, s24, 0xa1b000
    s_lshl_b32 s25, s13, 10
    s_add_u32 s88, s24, s25
    s_add_u32 s89, s88, 151552
    s_lshl_b32 s25, s13, 8
    s_add_u32 s24, s24, s25
    s_add_u32 s90, s24, 32768
    s_add_u32 s91, s90, 151552
    s_lshl_b32 s24, s13, 2
    s_add_u32 s24, s24, s40
    s_lshl_b32 s24, s24, 10
    s_add_u32 s47, s24, 0x1a00000
    s_lshl_b32 s24, s14, 7
    s_add_u32 s30, s47, s24
    s_lshl_b32 s24, s14, 2
    s_add_u32 s24, s24, s40
    s_lshl_b32 s24, s24, 5
    s_add_u32 s24, s24, s20
    s_lshl_b32 s24, s24, 7
    s_add_u32 s31, s24, 0x1a20000
    s_add_u32 m0, s95, 38400
    s_nop 0
    buffer_load_dwordx4 v8, s[52:55], s63 offen lds
    buffer_load_dwordx4 v9, s[52:55], s63 offen offset:1024 lds
    s_add_u32 m0, s95, 40448
    s_mov_b64 exec, 0xffff
    buffer_load_dwordx4 v10, s[52:55], s63 offen lds
    s_mov_b64 exec, -1
    s_add_u32 s63, s63, 122880
    s_cmp_eq_u32 s63, 2457600
    s_cselect_b32 s63, 0, s63
    s_add_u32 m0, s95, 51200
    s_nop 0
    buffer_load_dwordx4 v8, s[52:55], s63 offen lds
    buffer_load_dwordx4 v9, s[52:55], s63 offen offset:1024 lds
    s_add_u32 m0, s95, 53248
    s_mov_b64 exec, 0xffff
    buffer_load_dwordx4 v10, s[52:55], s63 offen lds
    s_mov_b64 exec, -1
    s_add_u32 s63, s63, 122880
    s_cmp_eq_u32 s63, 2457600
    s_cselect_b32 s63, 0, s63
    s_waitcnt vmcnt(14)
    s_barrier
    s_waitcnt vmcnt(3)
    s_barrier
    buffer_store_dwordx4 v[20:23], v1, s[8:11], s88 offen sc1
    buffer_store_dwordx4 v[20:23], v1, s[8:11], s89 offen sc1
    buffer_store_dword v20, v18, s[8:11], s90 offen sc1
    buffer_store_dword v20, v18, s[8:11], s91 offen sc1
    s_waitcnt vmcnt(4)
    s_barrier
    s_mov_b32 s56, s82
    s_mov_b32 s57, s83
    s_mov_b32 s58, 0x100
    s_mov_b32 s59, 0x00020000
    v_and_b32 v7, 1, v0
    v_lshlrev_b32 v7, 7, v7
    v_and_b32 v4, 7, v0
    v_lshlrev_b32 v4, 7, v4
    s_mov_b32 s43, 0
L_cntQ:
    buffer_load_dword v5, v7, s[56:59], 0 offen sc1
    s_add_u32 s43, s43, 1
    s_waitcnt vmcnt(0)
    v_cmp_eq_u32 vcc, 128, v5
    s_nop 0
    s_cmp_eq_u64 vcc, -1
    s_cbranch_scc1 L_cntQ_ok
    s_cmp_lt_u32 s43, 32768
    s_cbranch_scc1 L_cntQ
L_cntQ_ok:
    buffer_load_dword v30, v4, s[8:11], s47 offen offset:4 sc1
    s_barrier
L_aux2:
    s_mov_b32 s32, s80
    s_mov_b32 s33, s81
    s_mov_b32 s34, 0x280000
    s_mov_b32 s35, 0x00020000
    v_mov_b32 v6, 0
    s_mul_i32 s19, s40, 6144
    s_mul_i32 s17, s13, 196608
    s_add_u32 s17, s17, s19
    s_mul_i32 s24, s14, 24576
    s_add_u32 s18, s17, s24
    s_add_u32 s45, s18, 4096
    v_add_u32 v7, s19, v1
    v_add_u32 v2, 4096, v1
    v_mov_b32 v160, 1
    v_and_b32 v161, 31, v0
    v_lshlrev_b32 v162, 7, v161
    v_lshlrev_b32 v161, 2, v161
    v_min_u32 v163, 39, v0
    v_lshlrev_b32 v163, 7, v163
    s_lshl_b32 s24, s40, 13
    s_add_u32 s24, s24, 98304
    v_add_u32 v166, s24, v1
    s_mul_i32 s24, s28, 148
    s_lshl_b32 s25, s20, 2
    s_add_u32 s24, s24, s25
    s_lshl_b32 s24, s24, 10
    s_add_u32 s24, s24, 0xa00000
    s_cmp_lt_u32 s20, 27
    s_cselect_b32 s88, s24, 0x40000000
    s_add_u32 s89, s88, 151552
    s_mov_b32 s46, 0
    s_mul_i32 s24, s40, 27
    s_mul_i32 s38, s36, 148
    s_add_u32 s38, s38, s24
    s_lshl_b32 s38, s38, 10
    s_add_u32 s38, s38, 0xa00000
    s_mul_i32 s39, s37, 148
    s_add_u32 s39, s39, s24
    s_mul_i32 s39, s39, 5120
    s_add_u32 s39, s39, 0x1400000
    s_getreg_b32 s3, hwreg(HW_REG_XCC_ID, 0, 4)
    s_waitcnt vmcnt(0)
    v_cmp_eq_u32 vcc, s3, v30
    s_nop 0
    s_cmp_eq_u64 vcc, -1
    s_cselect_b32 s100, 0, 0
    s_barrier
    ds_read_b128 v[8:11], v7
    ds_read_b128 v[12:15], v7 offset:1024
    ds_read_b128 v[16:19], v7 offset:2048
    ds_read_b128 v[20:23], v7 offset:3072
    ds_read_b128 v[24:27], v7 offset:4096
    ds_read_b128 v[28:31], v7 offset:5120
    s_cmp_eq_u32 s100, 0
    s_cbranch_scc1 L_pub1
    s_waitcnt lgkmcnt(5)
    buffer_store_dwordx4 v[8:11], v1, s[8:11], s18 offen
    s_waitcnt lgkmcnt(4)
    buffer_store_dwordx4 v[12:15], v1, s[8:11], s18 offen offset:1024
    s_waitcnt lgkmcnt(3)
    buffer_store_dwordx4 v[16:19], v1, s[8:11], s18 offen offset:2048
    s_waitcnt lgkmcnt(2)
    buffer_store_dwordx4 v[20:23], v1, s[8:11], s18 offen offset:3072
    s_waitcnt lgkmcnt(1)
    buffer_store_dwordx4 v[24:27], v1, s[8:11], s45 offen
    s_waitcnt lgkmcnt(0)
    buffer_store_dwordx4 v[28:31], v1, s[8:11], s45 offen offset:1024
    s_waitcnt vmcnt(0)
    s_mov_b64 exec, 1
    buffer_store_dword v160, v6, s[8:11], s30 offen
    s_mov_b64 exec, -1
    s_branch L_pub2
L_pub1:
    s_waitcnt lgkmcnt(5)
    buffer_store_dwordx4 v[8:11], v1, s[8:11], s18 offen sc1
    s_waitcnt lgkmcnt(4)
    buffer_store_dwordx4 v[12:15], v1, s[8:11], s18 offen offset:1024 sc1
    s_waitcnt lgkmcnt(3)
    buffer_store_dwordx4 v[16:19], v1, s[8:11], s18 offen offset:2048 sc1
    s_waitcnt lgkmcnt(2)
    buffer_store_dwordx4 v[20:23], v1, s[8:11], s18 offen offset:3072 sc1
    s_waitcnt lgkmcnt(1)
    buffer_store_dwordx4 v[24:27], v1, s[8:11], s45 offen sc1
    s_waitcnt lgkmcnt(0)
    buffer_store_dwordx4 v[28:31], v1, s[8:11], s45 offen offset:1024 sc1
    s_waitcnt vmcnt(0)
    s_mov_b64 exec, 1
    buffer_store_dword v160, v6, s[8:11], s30 offen sc1
    s_mov_b64 exec, -1
L_pub2:
    s_add_u32 s24, s14, 1
    s_and_b32 s24, s24, 7
    s_bitcmp1_b32 s46, s24
    s_cbranch_scc1 L_kv1_ok
    s_mov_b32 s43, 0
L_kv1:
    buffer_load_dword v5, v4, s[8:11], s47 offen sc1
    s_add_u32 s43, s43, 1
    s_waitcnt vmcnt(0)
    v_cmp_eq_u32 vcc, 1, v5
    s_nop 0
    s_mov_b32 s46, vcc_lo
    s_bitcmp1_b32 s46, s24
    s_cbranch_scc1 L_kv1_ok
    s_cmp_lt_u32 s43, 32768
    s_cbranch_scc1 L_kv1
L_kv1_ok:
    s_mul_i32 s24, s24, 24576
    s_add_u32 m0, s19, 24576
    s_add_u32 s18, s17, s24
    s_add_u32 s45, s18, 4096
    buffer_load_dwordx4 v1, s[8:11], s18 offen sc1 lds
    buffer_load_dwordx4 v1, s[8:11], s18 offen offset:1024 sc1 lds
    buffer_load_dwordx4 v1, s[8:11], s18 offen offset:2048 sc1 lds
    buffer_load_dwordx4 v1, s[8:11], s18 offen offset:3072 sc1 lds
    s_add_u32 m0, s19, 28672
    s_nop 0
    buffer_load_dwordx4 v1, s[8:11], s45 offen sc1 lds
    buffer_load_dwordx4 v1, s[8:11], s45 offen offset:1024 sc1 lds
    s_waitcnt vmcnt(0)
    s_barrier
    ds_read_b128 v[8:11], v166
    ds_read_b128 v[12:15], v166 offset:1024
    ds_read_b128 v[16:19], v166 offset:2048
    ds_read_b128 v[20:23], v166 offset:3072
    ds_read_b128 v[24:27], v166 offset:4096
    ds_read_b128 v[28:31], v166 offset:5120
    ds_read_b128 v[32:35], v166 offset:6144
    ds_read_b128 v[36:39], v166 offset:7168
    s_add_u32 s24, s14, 2
    s_and_b32 s24, s24, 7
    s_bitcmp1_b32 s46, s24
    s_cbranch_scc1 L_kv2_ok
    s_mov_b32 s43, 0
L_kv2:
    buffer_load_dword v5, v4, s[8:11], s47 offen sc1
    s_add_u32 s43, s43, 1
    s_waitcnt vmcnt(0)
    v_cmp_eq_u32 vcc, 1, v5
    s_nop 0
    s_mov_b32 s46, vcc_lo
    s_bitcmp1_b32 s46, s24
    s_cbranch_scc1 L_kv2_ok
    s_cmp_lt_u32 s43, 32768
    s_cbranch_scc1 L_kv2
L_kv2_ok:
    s_mul_i32 s24, s24, 24576
    s_add_u32 m0, s19, 49152
    s_add_u32 s18, s17, s24
    s_add_u32 s45, s18, 4096
    buffer_load_dwordx4 v1, s[8:11], s18 offen sc1 lds
    buffer_load_dwordx4 v1, s[8:11], s18 offen offset:1024 sc1 lds
    buffer_load_dwordx4 v1, s[8:11], s18 offen offset:2048 sc1 lds
    buffer_load_dwordx4 v1, s[8:11], s18 offen offset:3072 sc1 lds
    s_add_u32 m0, s19, 53248
    s_nop 0
    buffer_load_dwordx4 v1, s[8:11], s45 offen sc1 lds
    buffer_load_dwordx4 v1, s[8:11], s45 offen offset:1024 sc1 lds
    s_waitcnt lgkmcnt(7)
    buffer_store_dwordx4 v[8:11], v1, s[8:11], s88 offen sc1
    s_waitcnt lgkmcnt(6)
    buffer_store_dwordx4 v[12:15], v1, s[8:11], s88 offen offset:1024 sc1
    s_waitcnt lgkmcnt(5)
    buffer_store_dwordx4 v[16:19], v1, s[8:11], s88 offen offset:2048 sc1
    s_waitcnt lgkmcnt(4)
    buffer_store_dwordx4 v[20:23], v1, s[8:11], s88 offen offset:3072 sc1
    s_waitcnt lgkmcnt(3)
    buffer_store_dwordx4 v[24:27], v1, s[8:11], s89 offen sc1
    s_waitcnt lgkmcnt(2)
    buffer_store_dwordx4 v[28:31], v1, s[8:11], s89 offen offset:1024 sc1
    s_waitcnt lgkmcnt(1)
    buffer_store_dwordx4 v[32:35], v1, s[8:11], s89 offen offset:2048 sc1
    s_waitcnt lgkmcnt(0)
    buffer_store_dwordx4 v[36:39], v1, s[8:11], s89 offen offset:3072 sc1
    s_and_b32 s24, s36, 6
    s_lshl_b32 s24, s24, 11
    s_lshl_b32 s26, s14, 14
    s_add_u32 s26, s26, s24
    s_add_u32 s26, s26, 0x1a20000
    s_lshl_b32 s27, s40, 13
    s_add_u32 s27, s27, 0x1a40000
    s_lshl_b32 s90, s37, 13
    s_add_u32 s90, s90, 0x1a40000
    s_waitcnt vmcnt(0)
    s_mov_b64 exec, 1
    buffer_store_dword v160, v6, s[8:11], s31 offen sc1
    s_mov_b64 exec, -1
    s_mov_b64 s[88:89], 0
    s_barrier
    s_add_u32 s24, s14, 3
    s_and_b32 s24, s24, 7
    s_bitcmp1_b32 s46, s24
    s_cbranch_scc1 L_kv3_ok
    s_mov_b32 s43, 0
L_kv3:
    buffer_load_dword v5, v4, s[8:11], s47 offen sc1
    s_add_u32 s43, s43, 1
    s_waitcnt vmcnt(0)
    v_cmp_eq_u32 vcc, 1, v5
    s_nop 0
    s_mov_b32 s46, vcc_lo
    s_bitcmp1_b32 s46, s24
    s_cbranch_scc1 L_kv3_ok
    s_cmp_lt_u32 s43, 32768
    s_cbranch_scc1 L_kv3
L_kv3_ok:
    s_mul_i32 s24, s24, 24576
    s_add_u32 m0, s19, 0
    s_add_u32 s18, s17, s24
    s_add_u32 s45, s18, 4096
    buffer_load_dwordx4 v1, s[8:11], s18 offen sc1 lds
    buffer_load_dwordx4 v1, s[8:11], s18 offen offset:1024 sc1 lds
    buffer_load_dwordx4 v1, s[8:11], s18 offen offset:2048 sc1 lds
    buffer_load_dwordx4 v1, s[8:11], s18 offen offset:3072 sc1 lds
    s_add_u32 m0, s19, 4096
    s_nop 0
    buffer_load_dwordx4 v1, s[8:11], s45 offen sc1 lds
    buffer_load_dwordx4 v1, s[8:11], s45 offen offset:1024 sc1 lds
    s_mov_b32 s43, 0
L_hw:
    buffer_load_dword v8, v163, s[8:11], s27 offen sc1
    buffer_load_dword v9, v163, s[8:11], s90 offen sc1
    buffer_load_dword v10, v162, s[8:11], s26 offen sc1
    s_add_u32 s43, s43, 1
    s_waitcnt vmcnt(0)
    v_and_b32 v8, v8, v9
    v_cmp_eq_u32 vcc, 1, v8
    v_cmp_eq_u32 s[92:93], 1, v10
    s_nop 0
    s_cmp_eq_u64 vcc, -1
    s_cselect_b32 s90, 0x40000000, s90
    s_cselect_b32 s27, 0x40000000, s27
    s_cselect_b64 s[88:89], -1, s[88:89]
    s_and_b64 vcc, s[88:89], s[92:93]
    s_cmp_eq_u64 vcc, -1
    s_cbranch_scc1 L_hw_ok
    s_cmp_lt_u32 s43, 32768
    s_cbranch_scc1 L_hw
L_hw_ok:
    buffer_load_dwordx4 v[8:11], v1, s[8:11], s38 offen sc1
    buffer_load_dwordx4 v[12:15], v1, s[8:11], s39 offen sc1
    buffer_load_dwordx4 v[16:19], v1, s[8:11], s39 offen offset:1024 sc1
    buffer_load_dwordx4 v[20:23], v1, s[8:11], s39 offen offset:2048 sc1
    buffer_load_dwordx4 v[24:27], v1, s[8:11], s39 offen offset:3072 sc1
    buffer_load_dwordx4 v[28:31], v2, s[8:11], s39 offen sc1
    s_add_u32 s38, s38, 1024
    s_add_u32 s39, s39, 5120
    buffer_load_dwordx4 v[32:35], v1, s[8:11], s38 offen sc1
    buffer_load_dwordx4 v[36:39], v1, s[8:11], s39 offen sc1
    buffer_load_dwordx4 v[40:43], v1, s[8:11], s39 offen offset:1024 sc1
    buffer_load_dwordx4 v[44:47], v1, s[8:11], s39 offen offset:2048 sc1
    buffer_load_dwordx4 v[48:51], v1, s[8:11], s39 offen offset:3072 sc1
    buffer_load_dwordx4 v[52:55], v2, s[8:11], s39 offen sc1
    s_add_u32 s38, s38, 1024
    s_add_u32 s39, s39, 5120
    s_barrier
    s_add_u32 s24, s14, 4
    s_and_b32 s24, s24, 7
    s_bitcmp1_b32 s46, s24
    s_cbranch_scc1 L_kv4_ok
    s_mov_b32 s43, 0
L_kv4:
    buffer_load_dword v5, v4, s[8:11], s47 offen sc1
    s_add_u32 s43, s43, 1
    s_waitcnt vmcnt(0)
    v_cmp_eq_u32 vcc, 1, v5
    s_nop 0
    s_mov_b32 s46, vcc_lo
    s_bitcmp1_b32 s46, s24
    s_cbranch_scc1 L_kv4_ok
    s_cmp_lt_u32 s43, 32768
    s_cbranch_scc1 L_kv4
L_kv4_ok:
    s_mul_i32 s24, s24, 24576
    s_add_u32 m0, s19, 24576
    s_add_u32 s18, s17, s24
    s_add_u32 s45, s18, 4096
    buffer_load_dwordx4 v1, s[8:11], s18 offen sc1 lds
    buffer_load_dwordx4 v1, s[8:11], s18 offen offset:1024 sc1 lds
    buffer_load_dwordx4 v1, s[8:11], s18 offen offset:2048 sc1 lds
    buffer_load_dwordx4 v1, s[8:11], s18 offen offset:3072 sc1 lds
    s_add_u32 m0, s19, 28672
    s_nop 0
    buffer_load_dwordx4 v1, s[8:11], s45 offen sc1 lds
    buffer_load_dwordx4 v1, s[8:11], s45 offen offset:1024 sc1 lds
    buffer_load_dwordx4 v[56:59], v1, s[8:11], s38 offen sc1
    buffer_load_dwordx4 v[60:63], v1, s[8:11], s39 offen sc1
    buffer_load_dwordx4 v[64:67], v1, s[8:11], s39 offen offset:1024 sc1
    buffer_load_dwordx4 v[68:71], v1, s[8:11], s39 offen offset:2048 sc1
    buffer_load_dwordx4 v[72:75], v1, s[8:11], s39 offen offset:3072 sc1
    buffer_load_dwordx4 v[76:79], v2, s[8:11], s39 offen sc1
    s_add_u32 s38, s38, 1024
    s_add_u32 s39, s39, 5120
    s_waitcnt vmcnt(18)
    v_mfma_f32_32x32x16_bf16 v[80:95], v[12:15], v[8:11], 0
    v_mfma_f32_32x32x16_bf16 v[96:111], v[16:19], v[8:11], 0
    v_mfma_f32_32x32x16_bf16 v[112:127], v[20:23], v[8:11], 0
    v_mfma_f32_32x32x16_bf16 v[128:143], v[24:27], v[8:11], 0
    v_mfma_f32_32x32x16_bf16 v[144:159], v[28:31], v[8:11], 0
    buffer_load_dwordx4 v[8:11], v1, s[8:11], s38 offen sc1
    buffer_load_dwordx4 v[12:15], v1, s[8:11], s39 offen sc1
    buffer_load_dwordx4 v[16:19], v1, s[8:11], s39 offen offset:1024 sc1
    buffer_load_dwordx4 v[20:23], v1, s[8:11], s39 offen offset:2048 sc1
    buffer_load_dwordx4 v[24:27], v1, s[8:11], s39 offen offset:3072 sc1
    buffer_load_dwordx4 v[28:31], v2, s[8:11], s39 offen sc1
    s_add_u32 s38, s38, 1024
    s_add_u32 s39, s39, 5120
    s_waitcnt vmcnt(18)
    v_mfma_f32_32x32x16_bf16 v[80:95], v[36:39], v[32:35], v[80:95]
    v_mfma_f32_32x32x16_bf16 v[96:111], v[40:43], v[32:35], v[96:111]
    v_mfma_f32_32x32x16_bf16 v[112:127], v[44:47], v[32:35], v[112:127]
    v_mfma_f32_32x32x16_bf16 v[128:143], v[48:51], v[32:35], v[128:143]
    v_mfma_f32_32x32x16_bf16 v[144:159], v[52:55], v[32:35], v[144:159]
    buffer_load_dwordx4 v[32:35], v1, s[8:11], s38 offen sc1
    buffer_load_dwordx4 v[36:39], v1, s[8:11], s39 offen sc1
    buffer_load_dwordx4 v[40:43], v1, s[8:11], s39 offen offset:1024 sc1
    buffer_load_dwordx4 v[44:47], v1, s[8:11], s39 offen offset:2048 sc1
    buffer_load_dwordx4 v[48:51], v1, s[8:11], s39 offen offset:3072 sc1
    buffer_load_dwordx4 v[52:55], v2, s[8:11], s39 offen sc1
    s_add_u32 s38, s38, 1024
    s_add_u32 s39, s39, 5120
    s_waitcnt vmcnt(12)
    v_mfma_f32_32x32x16_bf16 v[80:95], v[60:63], v[56:59], v[80:95]
    v_mfma_f32_32x32x16_bf16 v[96:111], v[64:67], v[56:59], v[96:111]
    v_mfma_f32_32x32x16_bf16 v[112:127], v[68:71], v[56:59], v[112:127]
    v_mfma_f32_32x32x16_bf16 v[128:143], v[72:75], v[56:59], v[128:143]
    v_mfma_f32_32x32x16_bf16 v[144:159], v[76:79], v[56:59], v[144:159]
    buffer_load_dwordx4 v[56:59], v1, s[8:11], s38 offen sc1
    buffer_load_dwordx4 v[60:63], v1, s[8:11], s39 offen sc1
    buffer_load_dwordx4 v[64:67], v1, s[8:11], s39 offen offset:1024 sc1
    buffer_load_dwordx4 v[68:71], v1, s[8:11], s39 offen offset:2048 sc1
    buffer_load_dwordx4 v[72:75], v1, s[8:11], s39 offen offset:3072 sc1
    buffer_load_dwordx4 v[76:79], v2, s[8:11], s39 offen sc1
    s_add_u32 s38, s38, 1024
    s_add_u32 s39, s39, 5120
    s_waitcnt vmcnt(12)
    v_mfma_f32_32x32x16_bf16 v[80:95], v[12:15], v[8:11], v[80:95]
    v_mfma_f32_32x32x16_bf16 v[96:111], v[16:19], v[8:11], v[96:111]
    v_mfma_f32_32x32x16_bf16 v[112:127], v[20:23], v[8:11], v[112:127]
    v_mfma_f32_32x32x16_bf16 v[128:143], v[24:27], v[8:11], v[128:143]
    v_mfma_f32_32x32x16_bf16 v[144:159], v[28:31], v[8:11], v[144:159]
    s_barrier
    s_add_u32 s24, s14, 5
    s_and_b32 s24, s24, 7
    s_bitcmp1_b32 s46, s24
    s_cbranch_scc1 L_kv5_ok
    s_mov_b32 s43, 0
L_kv5:
    buffer_load_dword v5, v4, s[8:11], s47 offen sc1
    s_add_u32 s43, s43, 1
    s_waitcnt vmcnt(0)
    v_cmp_eq_u32 vcc, 1, v5
    s_nop 0
    s_mov_b32 s46, vcc_lo
    s_bitcmp1_b32 s46, s24
    s_cbranch_scc1 L_kv5_ok
    s_cmp_lt_u32 s43, 32768
    s_cbranch_scc1 L_kv5
L_kv5_ok:
    s_mul_i32 s24, s24, 24576
    s_add_u32 m0, s19, 49152
    s_add_u32 s18, s17, s24
    s_add_u32 s45, s18, 4096
    buffer_load_dwordx4 v1, s[8:11], s18 offen sc1 lds
    buffer_load_dwordx4 v1, s[8:11], s18 offen offset:1024 sc1 lds
    buffer_load_dwordx4 v1, s[8:11], s18 offen offset:2048 sc1 lds
    buffer_load_dwordx4 v1, s[8:11], s18 offen offset:3072 sc1 lds
    s_add_u32 m0, s19, 53248
    s_nop 0
    buffer_load_dwordx4 v1, s[8:11], s45 offen sc1 lds
    buffer_load_dwordx4 v1, s[8:11], s45 offen offset:1024 sc1 lds
    s_lshl_b32 s25, s36, 7
    s_add_u32 s25, s25, 0x1800000
    buffer_load_dword v3, v161, s[8:11], s25 offen sc1
    s_mul_i32 s24, s37, 757760
    s_mul_i32 s93, s40, 51200
    s_add_u32 s93, s93, s24
    s_add_u32 s93, s93, 0x148d000
    s_mul_i32 s25, s40, 5120
    s_add_u32 m0, s25, 143360
    s_nop 0
    buffer_load_dwordx4 v1, s[8:11], s93 offen sc1 lds
    s_add_u32 s93, s93, 4096
    buffer_load_dwordx4 v1, s[8:11], s93 offen offset:1024 sc1 lds
    s_add_u32 s93, s93, 4096
    buffer_load_dwordx4 v1, s[8:11], s93 offen offset:2048 sc1 lds
    s_add_u32 s93, s93, 4096
    buffer_load_dwordx4 v1, s[8:11], s93 offen offset:3072 sc1 lds
    s_add_u32 m0, s25, 147456
    s_add_u32 s93, s93, 8192
    buffer_load_dwordx4 v1, s[8:11], s93 offen sc1 lds
    buffer_load_dwordx4 v[8:11], v1, s[8:11], s38 offen sc1
    buffer_load_dwordx4 v[12:15], v1, s[8:11], s39 offen sc1
    buffer_load_dwordx4 v[16:19], v1, s[8:11], s39 offen offset:1024 sc1
    buffer_load_dwordx4 v[20:23], v1, s[8:11], s39 offen offset:2048 sc1
    buffer_load_dwordx4 v[24:27], v1, s[8:11], s39 offen offset:3072 sc1
    buffer_load_dwordx4 v[28:31], v2, s[8:11], s39 offen sc1
    s_add_u32 s38, s38, 1024
    s_add_u32 s39, s39, 5120
    s_waitcnt vmcnt(24)
    v_mfma_f32_32x32x16_bf16 v[80:95], v[36:39], v[32:35], v[80:95]
    v_mfma_f32_32x32x16_bf16 v[96:111], v[40:43], v[32:35], v[96:111]
    v_mfma_f32_32x32x16_bf16 v[112:127], v[44:47], v[32:35], v[112:127]
    v_mfma_f32_32x32x16_bf16 v[128:143], v[48:51], v[32:35], v[128:143]
    v_mfma_f32_32x32x16_bf16 v[144:159], v[52:55], v[32:35], v[144:159]
    buffer_load_dwordx4 v[32:35], v1, s[8:11], s38 offen sc1
    buffer_load_dwordx4 v[36:39], v1, s[8:11], s39 offen sc1
    buffer_load_dwordx4 v[40:43], v1, s[8:11], s39 offen offset:1024 sc1
    buffer_load_dwordx4 v[44:47], v1, s[8:11], s39 offen offset:2048 sc1
    buffer_load_dwordx4 v[48:51], v1, s[8:11], s39 offen offset:3072 sc1
    buffer_load_dwordx4 v[52:55], v2, s[8:11], s39 offen sc1
    s_add_u32 s38, s38, 1024
    s_add_u32 s39, s39, 5120
    s_waitcnt vmcnt(24)
    v_mfma_f32_32x32x16_bf16 v[80:95], v[60:63], v[56:59], v[80:95]
    v_mfma_f32_32x32x16_bf16 v[96:111], v[64:67], v[56:59], v[96:111]
    v_mfma_f32_32x32x16_bf16 v[112:127], v[68:71], v[56:59], v[112:127]
    v_mfma_f32_32x32x16_bf16 v[128:143], v[72:75], v[56:59], v[128:143]
    v_mfma_f32_32x32x16_bf16 v[144:159], v[76:79], v[56:59], v[144:159]
    buffer_load_dwordx4 v[56:59], v1, s[8:11], s38 offen sc1
    buffer_load_dwordx4 v[60:63], v1, s[8:11], s39 offen sc1
    buffer_load_dwordx4 v[64:67], v1, s[8:11], s39 offen offset:1024 sc1
    buffer_load_dwordx4 v[68:71], v1, s[8:11], s39 offen offset:2048 sc1
    buffer_load_dwordx4 v[72:75], v1, s[8:11], s39 offen offset:3072 sc1
    buffer_load_dwordx4 v[76:79], v2, s[8:11], s39 offen sc1
    s_add_u32 s38, s38, 1024
    s_add_u32 s39, s39, 5120
    s_waitcnt vmcnt(12)
    v_mfma_f32_32x32x16_bf16 v[80:95], v[12:15], v[8:11], v[80:95]
    v_mfma_f32_32x32x16_bf16 v[96:111], v[16:19], v[8:11], v[96:111]
    v_mfma_f32_32x32x16_bf16 v[112:127], v[20:23], v[8:11], v[112:127]
    v_mfma_f32_32x32x16_bf16 v[128:143], v[24:27], v[8:11], v[128:143]
    v_mfma_f32_32x32x16_bf16 v[144:159], v[28:31], v[8:11], v[144:159]
    buffer_load_dwordx4 v[8:11], v1, s[8:11], s38 offen sc1
    buffer_load_dwordx4 v[12:15], v1, s[8:11], s39 offen sc1
    buffer_load_dwordx4 v[16:19], v1, s[8:11], s39 offen offset:1024 sc1
    buffer_load_dwordx4 v[20:23], v1, s[8:11], s39 offen offset:2048 sc1
    buffer_load_dwordx4 v[24:27], v1, s[8:11], s39 offen offset:3072 sc1
    buffer_load_dwordx4 v[28:31], v2, s[8:11], s39 offen sc1
    s_add_u32 s38, s38, 1024
    s_add_u32 s39, s39, 5120
    s_waitcnt vmcnt(12)
    v_mfma_f32_32x32x16_bf16 v[80:95], v[36:39], v[32:35], v[80:95]
    v_mfma_f32_32x32x16_bf16 v[96:111], v[40:43], v[32:35], v[96:111]
    v_mfma_f32_32x32x16_bf16 v[112:127], v[44:47], v[32:35], v[112:127]
    v_mfma_f32_32x32x16_bf16 v[128:143], v[48:51], v[32:35], v[128:143]
    v_mfma_f32_32x32x16_bf16 v[144:159], v[52:55], v[32:35], v[144:159]
    buffer_load_dwordx4 v[32:35], v1, s[8:11], s38 offen sc1
    buffer_load_dwordx4 v[36:39], v1, s[8:11], s39 offen sc1
    buffer_load_dwordx4 v[40:43], v1, s[8:11], s39 offen offset:1024 sc1
    buffer_load_dwordx4 v[44:47], v1, s[8:11], s39 offen offset:2048 sc1
    buffer_load_dwordx4 v[48:51], v1, s[8:11], s39 offen offset:3072 sc1
    buffer_load_dwordx4 v[52:55], v2, s[8:11], s39 offen sc1
    s_add_u32 s38, s38, 1024
    s_add_u32 s39, s39, 5120
    s_waitcnt vmcnt(12)
    v_mfma_f32_32x32x16_bf16 v[80:95], v[60:63], v[56:59], v[80:95]
    v_mfma_f32_32x32x16_bf16 v[96:111], v[64:67], v[56:59], v[96:111]
    v_mfma_f32_32x32x16_bf16 v[112:127], v[68:71], v[56:59], v[112:127]
    v_mfma_f32_32x32x16_bf16 v[128:143], v[72:75], v[56:59], v[128:143]
    v_mfma_f32_32x32x16_bf16 v[144:159], v[76:79], v[56:59], v[144:159]
    s_barrier
    s_add_u32 s24, s14, 6
    s_and_b32 s24, s24, 7
    s_bitcmp1_b32 s46, s24
    s_cbranch_scc1 L_kv6_ok
    s_mov_b32 s43, 0
L_kv6:
    buffer_load_dword v5, v4, s[8:11], s47 offen sc1
    s_add_u32 s43, s43, 1
    s_waitcnt vmcnt(0)
    v_cmp_eq_u32 vcc, 1, v5
    s_nop 0
    s_mov_b32 s46, vcc_lo
    s_bitcmp1_b32 s46, s24
    s_cbranch_scc1 L_kv6_ok
    s_cmp_lt_u32 s43, 32768
    s_cbranch_scc1 L_kv6
L_kv6_ok:
    s_mul_i32 s24, s24, 24576
    s_add_u32 m0, s19, 0
    s_add_u32 s18, s17, s24
    s_add_u32 s45, s18, 4096
    buffer_load_dwordx4 v1, s[8:11], s18 offen sc1 lds
    buffer_load_dwordx4 v1, s[8:11], s18 offen offset:1024 sc1 lds
    buffer_load_dwordx4 v1, s[8:11], s18 offen offset:2048 sc1 lds
    buffer_load_dwordx4 v1, s[8:11], s18 offen offset:3072 sc1 lds
    s_add_u32 m0, s19, 4096
    s_nop 0
    buffer_load_dwordx4 v1, s[8:11], s45 offen sc1 lds
    buffer_load_dwordx4 v1, s[8:11], s45 offen offset:1024 sc1 lds
    s_mul_i32 s90, s37, 757760
    s_lshl_b32 s24, s40, 10
    s_add_u32 s90, s90, s24
    s_add_u32 s90, s90, 0x1487000
    s_mul_i32 s91, s40, 17408
    s_add_u32 s91, s91, 73728
    s_add_u32 m0, s91, 0
    s_nop 0
    buffer_load_dwordx4 v1, s[8:11], s90 offen sc1 lds
    s_add_u32 s90, s90, 5120
    s_add_u32 m0, s91, 1024
    s_nop 0
    buffer_load_dwordx4 v1, s[8:11], s90 offen sc1 lds
    s_add_u32 s90, s90, 5120
    s_add_u32 m0, s91, 2048
    s_nop 0
    buffer_load_dwordx4 v1, s[8:11], s90 offen sc1 lds
    s_add_u32 s90, s90, 5120
    s_add_u32 m0, s91, 3072
    s_nop 0
    buffer_load_dwordx4 v1, s[8:11], s90 offen sc1 lds
    s_add_u32 s90, s90, 5120
    s_add_u32 m0, s91, 4096
    s_nop 0
    buffer_load_dwordx4 v1, s[8:11], s90 offen sc1 lds
    s_add_u32 s90, s90, 5120
    buffer_load_dwordx4 v[56:59], v1, s[8:11], s38 offen sc1
    buffer_load_dwordx4 v[60:63], v1, s[8:11], s39 offen sc1
    buffer_load_dwordx4 v[64:67], v1, s[8:11], s39 offen offset:1024 sc1
    buffer_load_dwordx4 v[68:71], v1, s[8:11], s39 offen offset:2048 sc1
    buffer_load_dwordx4 v[72:75], v1, s[8:11], s39 offen offset:3072 sc1
    buffer_load_dwordx4 v[76:79], v2, s[8:11], s39 offen sc1
    s_add_u32 s38, s38, 1024
    s_add_u32 s39, s39, 5120
    s_waitcnt vmcnt(23)
    v_mfma_f32_32x32x16_bf16 v[80:95], v[12:15], v[8:11], v[80:95]
    v_mfma_f32_32x32x16_bf16 v[96:111], v[16:19], v[8:11], v[96:111]
    v_mfma_f32_32x32x16_bf16 v[112:127], v[20:23], v[8:11], v[112:127]
    v_mfma_f32_32x32x16_bf16 v[128:143], v[24:27], v[8:11], v[128:143]
    v_mfma_f32_32x32x16_bf16 v[144:159], v[28:31], v[8:11], v[144:159]
    buffer_load_dwordx4 v[8:11], v1, s[8:11], s38 offen sc1
    buffer_load_dwordx4 v[12:15], v1, s[8:11], s39 offen sc1
    buffer_load_dwordx4 v[16:19], v1, s[8:11], s39 offen offset:1024 sc1
    buffer_load_dwordx4 v[20:23], v1, s[8:11], s39 offen offset:2048 sc1
    buffer_load_dwordx4 v[24:27], v1, s[8:11], s39 offen offset:3072 sc1
    buffer_load_dwordx4 v[28:31], v2, s[8:11], s39 offen sc1
    s_add_u32 s38, s38, 1024
    s_add_u32 s39, s39, 5120
    s_waitcnt vmcnt(23)
    v_mfma_f32_32x32x16_bf16 v[80:95], v[36:39], v[32:35], v[80:95]
    v_mfma_f32_32x32x16_bf16 v[96:111], v[40:43], v[32:35], v[96:111]
    v_mfma_f32_32x32x16_bf16 v[112:127], v[44:47], v[32:35], v[112:127]
    v_mfma_f32_32x32x16_bf16 v[128:143], v[48:51], v[32:35], v[128:143]
    v_mfma_f32_32x32x16_bf16 v[144:159], v[52:55], v[32:35], v[144:159]
    buffer_load_dwordx4 v[32:35], v1, s[8:11], s38 offen sc1
    buffer_load_dwordx4 v[36:39], v1, s[8:11], s39 offen sc1
    buffer_load_dwordx4 v[40:43], v1, s[8:11], s39 offen offset:1024 sc1
    buffer_load_dwordx4 v[44:47], v1, s[8:11], s39 offen offset:2048 sc1
    buffer_load_dwordx4 v[48:51], v1, s[8:11], s39 offen offset:3072 sc1
    buffer_load_dwordx4 v[52:55], v2, s[8:11], s39 offen sc1
    s_add_u32 s38, s38, 1024
    s_add_u32 s39, s39, 5120
    s_waitcnt vmcnt(12)
    v_mfma_f32_32x32x16_bf16 v[80:95], v[60:63], v[56:59], v[80:95]
    v_mfma_f32_32x32x16_bf16 v[96:111], v[64:67], v[56:59], v[96:111]
    v_mfma_f32_32x32x16_bf16 v[112:127], v[68:71], v[56:59], v[112:127]
    v_mfma_f32_32x32x16_bf16 v[128:143], v[72:75], v[56:59], v[128:143]
    v_mfma_f32_32x32x16_bf16 v[144:159], v[76:79], v[56:59], v[144:159]
    buffer_load_dwordx4 v[56:59], v1, s[8:11], s38 offen sc1
    buffer_load_dwordx4 v[60:63], v1, s[8:11], s39 offen sc1
    buffer_load_dwordx4 v[64:67], v1, s[8:11], s39 offen offset:1024 sc1
    buffer_load_dwordx4 v[68:71], v1, s[8:11], s39 offen offset:2048 sc1
    buffer_load_dwordx4 v[72:75], v1, s[8:11], s39 offen offset:3072 sc1
    buffer_load_dwordx4 v[76:79], v2, s[8:11], s39 offen sc1
    s_add_u32 s38, s38, 1024
    s_add_u32 s39, s39, 5120
    s_waitcnt vmcnt(12)
    v_mfma_f32_32x32x16_bf16 v[80:95], v[12:15], v[8:11], v[80:95]
    v_mfma_f32_32x32x16_bf16 v[96:111], v[16:19], v[8:11], v[96:111]
    v_mfma_f32_32x32x16_bf16 v[112:127], v[20:23], v[8:11], v[112:127]
    v_mfma_f32_32x32x16_bf16 v[128:143], v[24:27], v[8:11], v[128:143]
    v_mfma_f32_32x32x16_bf16 v[144:159], v[28:31], v[8:11], v[144:159]
    buffer_load_dwordx4 v[8:11], v1, s[8:11], s38 offen sc1
    buffer_load_dwordx4 v[12:15], v1, s[8:11], s39 offen sc1
    buffer_load_dwordx4 v[16:19], v1, s[8:11], s39 offen offset:1024 sc1
    buffer_load_dwordx4 v[20:23], v1, s[8:11], s39 offen offset:2048 sc1
    buffer_load_dwordx4 v[24:27], v1, s[8:11], s39 offen offset:3072 sc1
    buffer_load_dwordx4 v[28:31], v2, s[8:11], s39 offen sc1
    s_add_u32 s38, s38, 1024
    s_add_u32 s39, s39, 5120
    s_waitcnt vmcnt(12)
    v_mfma_f32_32x32x16_bf16 v[80:95], v[36:39], v[32:35], v[80:95]
    v_mfma_f32_32x32x16_bf16 v[96:111], v[40:43], v[32:35], v[96:111]
    v_mfma_f32_32x32x16_bf16 v[112:127], v[44:47], v[32:35], v[112:127]
    v_mfma_f32_32x32x16_bf16 v[128:143], v[48:51], v[32:35], v[128:143]
    v_mfma_f32_32x32x16_bf16 v[144:159], v[52:55], v[32:35], v[144:159]
    s_barrier
    s_add_u32 s24, s14, 7
    s_and_b32 s24, s24, 7
    s_bitcmp1_b32 s46, s24
    s_cbranch_scc1 L_kv7_ok
    s_mov_b32 s43, 0
L_kv7:
    buffer_load_dword v5, v4, s[8:11], s47 offen sc1
    s_add_u32 s43, s43, 1
    s_waitcnt vmcnt(0)
    v_cmp_eq_u32 vcc, 1, v5
    s_nop 0
    s_mov_b32 s46, vcc_lo
    s_bitcmp1_b32 s46, s24
    s_cbranch_scc1 L_kv7_ok
    s_cmp_lt_u32 s43, 32768
    s_cbranch_scc1 L_kv7
L_kv7_ok:
    s_mul_i32 s24, s24, 24576
    s_add_u32 m0, s19, 24576
    s_add_u32 s18, s17, s24
    s_add_u32 s45, s18, 4096
    buffer_load_dwordx4 v1, s[8:11], s18 offen sc1 lds
    buffer_load_dwordx4 v1, s[8:11], s18 offen offset:1024 sc1 lds
    buffer_load_dwordx4 v1, s[8:11], s18 offen offset:2048 sc1 lds
    buffer_load_dwordx4 v1, s[8:11], s18 offen offset:3072 sc1 lds
    s_add_u32 m0, s19, 28672
    s_nop 0
    buffer_load_dwordx4 v1, s[8:11], s45 offen sc1 lds
    buffer_load_dwordx4 v1, s[8:11], s45 offen offset:1024 sc1 lds
    s_add_u32 m0, s91, 5120
    s_nop 0
    buffer_load_dwordx4 v1, s[8:11], s90 offen sc1 lds
    s_add_u32 s90, s90, 5120
    s_add_u32 m0, s91, 6144
    s_nop 0
    buffer_load_dwordx4 v1, s[8:11], s90 offen sc1 lds
    s_add_u32 s90, s90, 5120
    s_add_u32 m0, s91, 7168
    s_nop 0
    buffer_load_dwordx4 v1, s[8:11], s90 offen sc1 lds
    s_add_u32 s90, s90, 5120
    s_add_u32 m0, s91, 8192
    s_nop 0
    buffer_load_dwordx4 v1, s[8:11], s90 offen sc1 lds
    s_add_u32 s90, s90, 5120
    s_add_u32 m0, s91, 9216
    s_nop 0
    buffer_load_dwordx4 v1, s[8:11], s90 offen sc1 lds
    s_add_u32 s90, s90, 5120
    s_add_u32 m0, s91, 10240
    s_nop 0
    buffer_load_dwordx4 v1, s[8:11], s90 offen sc1 lds
    s_add_u32 s90, s90, 5120
    buffer_load_dwordx4 v[32:35], v1, s[8:11], s38 offen sc1
    buffer_load_dwordx4 v[36:39], v1, s[8:11], s39 offen sc1
    buffer_load_dwordx4 v[40:43], v1, s[8:11], s39 offen offset:1024 sc1
    buffer_load_dwordx4 v[44:47], v1, s[8:11], s39 offen offset:2048 sc1
    buffer_load_dwordx4 v[48:51], v1, s[8:11], s39 offen offset:3072 sc1
    buffer_load_dwordx4 v[52:55], v2, s[8:11], s39 offen sc1
    s_add_u32 s38, s38, 1024
    s_add_u32 s39, s39, 5120
    s_waitcnt vmcnt(24)
    v_mfma_f32_32x32x16_bf16 v[80:95], v[60:63], v[56:59], v[80:95]
    v_mfma_f32_32x32x16_bf16 v[96:111], v[64:67], v[56:59], v[96:111]
    v_mfma_f32_32x32x16_bf16 v[112:127], v[68:71], v[56:59], v[112:127]
    v_mfma_f32_32x32x16_bf16 v[128:143], v[72:75], v[56:59], v[128:143]
    v_mfma_f32_32x32x16_bf16 v[144:159], v[76:79], v[56:59], v[144:159]
    buffer_load_dwordx4 v[56:59], v1, s[8:11], s38 offen sc1
    buffer_load_dwordx4 v[60:63], v1, s[8:11], s39 offen sc1
    buffer_load_dwordx4 v[64:67], v1, s[8:11], s39 offen offset:1024 sc1
    buffer_load_dwordx4 v[68:71], v1, s[8:11], s39 offen offset:2048 sc1
    buffer_load_dwordx4 v[72:75], v1, s[8:11], s39 offen offset:3072 sc1
    buffer_load_dwordx4 v[76:79], v2, s[8:11], s39 offen sc1
    s_add_u32 s38, s38, 1024
    s_add_u32 s39, s39, 5120
    s_waitcnt vmcnt(24)
    v_mfma_f32_32x32x16_bf16 v[80:95], v[12:15], v[8:11], v[80:95]
    v_mfma_f32_32x32x16_bf16 v[96:111], v[16:19], v[8:11], v[96:111]
    v_mfma_f32_32x32x16_bf16 v[112:127], v[20:23], v[8:11], v[112:127]
    v_mfma_f32_32x32x16_bf16 v[128:143], v[24:27], v[8:11], v[128:143]
    v_mfma_f32_32x32x16_bf16 v[144:159], v[28:31], v[8:11], v[144:159]
    buffer_load_dwordx4 v[8:11], v1, s[8:11], s38 offen sc1
    buffer_load_dwordx4 v[12:15], v1, s[8:11], s39 offen sc1
    buffer_load_dwordx4 v[16:19], v1, s[8:11], s39 offen offset:1024 sc1
    buffer_load_dwordx4 v[20:23], v1, s[8:11], s39 offen offset:2048 sc1
    buffer_load_dwordx4 v[24:27], v1, s[8:11], s39 offen offset:3072 sc1
    buffer_load_dwordx4 v[28:31], v2, s[8:11], s39 offen sc1
    s_add_u32 s38, s38, 1024
    s_add_u32 s39, s39, 5120
    s_waitcnt vmcnt(12)
    v_mfma_f32_32x32x16_bf16 v[80:95], v[36:39], v[32:35], v[80:95]
    v_mfma_f32_32x32x16_bf16 v[96:111], v[40:43], v[32:35], v[96:111]
    v_mfma_f32_32x32x16_bf16 v[112:127], v[44:47], v[32:35], v[112:127]
    v_mfma_f32_32x32x16_bf16 v[128:143], v[48:51], v[32:35], v[128:143]
    v_mfma_f32_32x32x16_bf16 v[144:159], v[52:55], v[32:35], v[144:159]
    buffer_load_dwordx4 v[32:35], v1, s[8:11], s38 offen sc1
    buffer_load_dwordx4 v[36:39], v1, s[8:11], s39 offen sc1
    buffer_load_dwordx4 v[40:43], v1, s[8:11], s39 offen offset:1024 sc1
    buffer_load_dwordx4 v[44:47], v1, s[8:11], s39 offen offset:2048 sc1
    buffer_load_dwordx4 v[48:51], v1, s[8:11], s39 offen offset:3072 sc1
    buffer_load_dwordx4 v[52:55], v2, s[8:11], s39 offen sc1
    s_add_u32 s38, s38, 1024
    s_add_u32 s39, s39, 5120
    s_waitcnt vmcnt(12)
    v_mfma_f32_32x32x16_bf16 v[80:95], v[60:63], v[56:59], v[80:95]
    v_mfma_f32_32x32x16_bf16 v[96:111], v[64:67], v[56:59], v[96:111]
    v_mfma_f32_32x32x16_bf16 v[112:127], v[68:71], v[56:59], v[112:127]
    v_mfma_f32_32x32x16_bf16 v[128:143], v[72:75], v[56:59], v[128:143]
    v_mfma_f32_32x32x16_bf16 v[144:159], v[76:79], v[56:59], v[144:159]
    buffer_load_dwordx4 v[56:59], v1, s[8:11], s38 offen sc1
    buffer_load_dwordx4 v[60:63], v1, s[8:11], s39 offen sc1
    buffer_load_dwordx4 v[64:67], v1, s[8:11], s39 offen offset:1024 sc1
    buffer_load_dwordx4 v[68:71], v1, s[8:11], s39 offen offset:2048 sc1
    buffer_load_dwordx4 v[72:75], v1, s[8:11], s39 offen offset:3072 sc1
    buffer_load_dwordx4 v[76:79], v2, s[8:11], s39 offen sc1
    s_add_u32 s38, s38, 1024
    s_add_u32 s39, s39, 5120
    s_waitcnt vmcnt(12)
    v_mfma_f32_32x32x16_bf16 v[80:95], v[12:15], v[8:11], v[80:95]
    v_mfma_f32_32x32x16_bf16 v[96:111], v[16:19], v[8:11], v[96:111]
    v_mfma_f32_32x32x16_bf16 v[112:127], v[20:23], v[8:11], v[112:127]
    v_mfma_f32_32x32x16_bf16 v[128:143], v[24:27], v[8:11], v[128:143]
    v_mfma_f32_32x32x16_bf16 v[144:159], v[28:31], v[8:11], v[144:159]
    s_barrier
    s_mul_i32 s24, s37, 757760
    s_add_u32 s24, s24, 0x1487000
    s_lshl_b32 s25, s40, 10
    s_add_u32 s92, s24, s25
    s_add_u32 s92, s92, 184320
    s_mul_i32 s93, s40, 51200
    s_add_u32 s93, s93, s24
    s_add_u32 s93, s93, 24576
    s_add_u32 m0, s25, 49152
    s_add_u32 s24, s93, 25600
    buffer_load_dwordx4 v1, s[8:11], s24 offen sc1 lds
    s_lshl_b32 s25, s40, 12
    s_add_u32 m0, s25, 57344
    s_nop 0
    buffer_load_dwordx4 v1, s[8:11], s92 offen sc1 lds
    s_add_u32 s92, s92, 4096
    buffer_load_dwordx4 v1, s[8:11], s92 offen offset:1024 sc1 lds
    s_add_u32 s92, s92, 4096
    buffer_load_dwordx4 v1, s[8:11], s92 offen offset:2048 sc1 lds
    s_add_u32 s92, s92, 4096
    buffer_load_dwordx4 v1, s[8:11], s92 offen offset:3072 sc1 lds
    s_add_u32 m0, s91, 11264
    s_nop 0
    buffer_load_dwordx4 v1, s[8:11], s90 offen sc1 lds
    s_add_u32 s90, s90, 5120
    s_add_u32 m0, s91, 12288
    s_nop 0
    buffer_load_dwordx4 v1, s[8:11], s90 offen sc1 lds
    s_add_u32 s90, s90, 5120
    s_add_u32 m0, s91, 13312
    s_nop 0
    buffer_load_dwordx4 v1, s[8:11], s90 offen sc1 lds
    s_add_u32 s90, s90, 5120
    s_add_u32 m0, s91, 14336
    s_nop 0
    buffer_load_dwordx4 v1, s[8:11], s90 offen sc1 lds
    s_add_u32 s90, s90, 5120
    s_add_u32 m0, s91, 15360
    s_nop 0
    buffer_load_dwordx4 v1, s[8:11], s90 offen sc1 lds
    s_add_u32 s90, s90, 5120
    s_add_u32 m0, s91, 16384
    s_nop 0
    buffer_load_dwordx4 v1, s[8:11], s90 offen sc1 lds
    s_add_u32 s90, s90, 5120
    buffer_load_dwordx4 v[8:11], v1, s[8:11], s38 offen sc1
    buffer_load_dwordx4 v[12:15], v1, s[8:11], s39 offen sc1
    buffer_load_dwordx4 v[16:19], v1, s[8:11], s39 offen offset:1024 sc1
    buffer_load_dwordx4 v[20:23], v1, s[8:11], s39 offen offset:2048 sc1
    buffer_load_dwordx4 v[24:27], v1, s[8:11], s39 offen offset:3072 sc1
    buffer_load_dwordx4 v[28:31], v2, s[8:11], s39 offen sc1
    s_add_u32 s38, s38, 1024
    s_add_u32 s39, s39, 5120
    s_waitcnt vmcnt(23)
    v_mfma_f32_32x32x16_bf16 v[80:95], v[36:39], v[32:35], v[80:95]
    v_mfma_f32_32x32x16_bf16 v[96:111], v[40:43], v[32:35], v[96:111]
    v_mfma_f32_32x32x16_bf16 v[112:127], v[44:47], v[32:35], v[112:127]
    v_mfma_f32_32x32x16_bf16 v[128:143], v[48:51], v[32:35], v[128:143]
    v_mfma_f32_32x32x16_bf16 v[144:159], v[52:55], v[32:35], v[144:159]
    buffer_load_dwordx4 v[32:35], v1, s[8:11], s38 offen sc1
    buffer_load_dwordx4 v[36:39], v1, s[8:11], s39 offen sc1
    buffer_load_dwordx4 v[40:43], v1, s[8:11], s39 offen offset:1024 sc1
    buffer_load_dwordx4 v[44:47], v1, s[8:11], s39 offen offset:2048 sc1
    buffer_load_dwordx4 v[48:51], v1, s[8:11], s39 offen offset:3072 sc1
    buffer_load_dwordx4 v[52:55], v2, s[8:11], s39 offen sc1
    s_add_u32 s38, s38, 1024
    s_add_u32 s39, s39, 5120
    s_waitcnt vmcnt(23)
    v_mfma_f32_32x32x16_bf16 v[80:95], v[60:63], v[56:59], v[80:95]
    v_mfma_f32_32x32x16_bf16 v[96:111], v[64:67], v[56:59], v[96:111]
    v_mfma_f32_32x32x16_bf16 v[112:127], v[68:71], v[56:59], v[112:127]
    v_mfma_f32_32x32x16_bf16 v[128:143], v[72:75], v[56:59], v[128:143]
    v_mfma_f32_32x32x16_bf16 v[144:159], v[76:79], v[56:59], v[144:159]
    buffer_load_dwordx4 v[56:59], v1, s[8:11], s38 offen sc1
    buffer_load_dwordx4 v[60:63], v1, s[8:11], s39 offen sc1
    buffer_load_dwordx4 v[64:67], v1, s[8:11], s39 offen offset:1024 sc1
    buffer_load_dwordx4 v[68:71], v1, s[8:11], s39 offen offset:2048 sc1
    buffer_load_dwordx4 v[72:75], v1, s[8:11], s39 offen offset:3072 sc1
    buffer_load_dwordx4 v[76:79], v2, s[8:11], s39 offen sc1
    s_add_u32 s38, s38, 1024
    s_add_u32 s39, s39, 5120
    s_waitcnt vmcnt(12)
    v_mfma_f32_32x32x16_bf16 v[80:95], v[12:15], v[8:11], v[80:95]
    v_mfma_f32_32x32x16_bf16 v[96:111], v[16:19], v[8:11], v[96:111]
    v_mfma_f32_32x32x16_bf16 v[112:127], v[20:23], v[8:11], v[112:127]
    v_mfma_f32_32x32x16_bf16 v[128:143], v[24:27], v[8:11], v[128:143]
    v_mfma_f32_32x32x16_bf16 v[144:159], v[28:31], v[8:11], v[144:159]
    buffer_load_dwordx4 v[8:11], v1, s[8:11], s38 offen sc1
    buffer_load_dwordx4 v[12:15], v1, s[8:11], s39 offen sc1
    buffer_load_dwordx4 v[16:19], v1, s[8:11], s39 offen offset:1024 sc1
    buffer_load_dwordx4 v[20:23], v1, s[8:11], s39 offen offset:2048 sc1
    buffer_load_dwordx4 v[24:27], v1, s[8:11], s39 offen offset:3072 sc1
    buffer_load_dwordx4 v[28:31], v2, s[8:11], s39 offen sc1
    s_add_u32 s38, s38, 1024
    s_add_u32 s39, s39, 5120
    s_waitcnt vmcnt(12)
    v_mfma_f32_32x32x16_bf16 v[80:95], v[36:39], v[32:35], v[80:95]
    v_mfma_f32_32x32x16_bf16 v[96:111], v[40:43], v[32:35], v[96:111]
    v_mfma_f32_32x32x16_bf16 v[112:127], v[44:47], v[32:35], v[112:127]
    v_mfma_f32_32x32x16_bf16 v[128:143], v[48:51], v[32:35], v[128:143]
    v_mfma_f32_32x32x16_bf16 v[144:159], v[52:55], v[32:35], v[144:159]
    buffer_load_dwordx4 v[32:35], v1, s[8:11], s38 offen sc1
    buffer_load_dwordx4 v[36:39], v1, s[8:11], s39 offen sc1
    buffer_load_dwordx4 v[40:43], v1, s[8:11], s39 offen offset:1024 sc1
    buffer_load_dwordx4 v[44:47], v1, s[8:11], s39 offen offset:2048 sc1
    buffer_load_dwordx4 v[48:51], v1, s[8:11], s39 offen offset:3072 sc1
    buffer_load_dwordx4 v[52:55], v2, s[8:11], s39 offen sc1
    s_add_u32 s38, s38, 1024
    s_add_u32 s39, s39, 5120
    s_waitcnt vmcnt(12)
    v_mfma_f32_32x32x16_bf16 v[80:95], v[60:63], v[56:59], v[80:95]
    v_mfma_f32_32x32x16_bf16 v[96:111], v[64:67], v[56:59], v[96:111]
    v_mfma_f32_32x32x16_bf16 v[112:127], v[68:71], v[56:59], v[112:127]
    v_mfma_f32_32x32x16_bf16 v[128:143], v[72:75], v[56:59], v[128:143]
    v_mfma_f32_32x32x16_bf16 v[144:159], v[76:79], v[56:59], v[144:159]
    s_barrier
    buffer_load_dwordx4 v[56:59], v1, s[8:11], s38 offen sc1
    buffer_load_dwordx4 v[60:63], v1, s[8:11], s39 offen sc1
    buffer_load_dwordx4 v[64:67], v1, s[8:11], s39 offen offset:1024 sc1
    buffer_load_dwordx4 v[68:71], v1, s[8:11], s39 offen offset:2048 sc1
    buffer_load_dwordx4 v[72:75], v1, s[8:11], s39 offen offset:3072 sc1
    buffer_load_dwordx4 v[76:79], v2, s[8:11], s39 offen sc1
    s_add_u32 s38, s38, 1024
    s_add_u32 s39, s39, 5120
    v_sub_f32 v6, 1.0, v3
    v_sub_f32 v7, 1.0, v3
    v_add_u32 v166, s91, v1
    s_mov_b32 s41, s40
    s_mov_b32 s42, 0
    s_mul_i32 s24, s36, 40960
    s_mul_i32 s25, s37, 320
    s_add_u32 s24, s24, s25
    s_lshl_b32 s25, s41, 6
    s_add_u32 s24, s24, s25
    v_and_b32 v164, 31, v0
    v_mul_u32_u24 v164, 1280, v164
    v_lshrrev_b32 v165, 5, v0
    v_lshlrev_b32 v165, 4, v165
    v_add3_u32 v164, v164, v165, s24
    s_lshl_b32 s24, s42, 10
    s_add_u32 s24, s24, 0
    v_add_u32 v165, s24, v1
    s_lshl_b32 s24, s40, 12
    s_add_u32 s24, s24, 40960
    v_add_u32 v3, s24, v1
    s_barrier
    v_add_u32 v2, 2048, v3
    s_mov_b32 s39, s90
    s_waitcnt vmcnt(12)
    v_mfma_f32_32x32x16_bf16 v[80:95], v[12:15], v[8:11], v[80:95]
    v_mfma_f32_32x32x16_bf16 v[96:111], v[16:19], v[8:11], v[96:111]
    v_mfma_f32_32x32x16_bf16 v[112:127], v[20:23], v[8:11], v[112:127]
    v_mfma_f32_32x32x16_bf16 v[128:143], v[24:27], v[8:11], v[128:143]
    v_mfma_f32_32x32x16_bf16 v[144:159], v[28:31], v[8:11], v[144:159]
    ds_read_b128 v[28:31], v166
    s_waitcnt vmcnt(6)
    v_mfma_f32_32x32x16_bf16 v[80:95], v[36:39], v[32:35], v[80:95]
    v_mfma_f32_32x32x16_bf16 v[96:111], v[40:43], v[32:35], v[96:111]
    v_mfma_f32_32x32x16_bf16 v[112:127], v[44:47], v[32:35], v[112:127]
    v_mfma_f32_32x32x16_bf16 v[128:143], v[48:51], v[32:35], v[128:143]
    v_mfma_f32_32x32x16_bf16 v[144:159], v[52:55], v[32:35], v[144:159]
    ds_read_b128 v[32:35], v166 offset:1024
    ds_read_b128 v[36:39], v166 offset:2048
    ds_read_b128 v[40:43], v166 offset:3072
    ds_read_b128 v[44:47], v166 offset:4096
    ds_read_b128 v[48:51], v166 offset:5120
    ds_read_b128 v[52:55], v166 offset:6144
    s_waitcnt vmcnt(0)
    v_mfma_f32_32x32x16_bf16 v[80:95], v[60:63], v[56:59], v[80:95]
    v_mfma_f32_32x32x16_bf16 v[96:111], v[64:67], v[56:59], v[96:111]
    v_mfma_f32_32x32x16_bf16 v[112:127], v[68:71], v[56:59], v[112:127]
    v_mfma_f32_32x32x16_bf16 v[128:143], v[72:75], v[56:59], v[128:143]
    v_mfma_f32_32x32x16_bf16 v[144:159], v[76:79], v[56:59], v[144:159]
    ds_read_b128 v[56:59], v166 offset:7168
    ds_read_b128 v[60:63], v166 offset:8192
    ds_read_b128 v[64:67], v166 offset:9216
    ds_read_b128 v[68:71], v166 offset:10240
    ds_read_b128 v[72:75], v166 offset:11264
    ds_read_b128 v[76:79], v166 offset:12288
    s_cmp_eq_u32 s40, 0
    s_cbranch_scc0 L_aux_r1
    s_nop 7
    v_pk_mul_f32 v[8:9], v[80:81], v[6:7]
    v_pk_mul_f32 v[10:11], v[82:83], v[6:7]
    v_pk_mul_f32 v[12:13], v[84:85], v[6:7]
    v_pk_mul_f32 v[14:15], v[86:87], v[6:7]
    v_pk_mul_f32 v[16:17], v[88:89], v[6:7]
    v_pk_mul_f32 v[18:19], v[90:91], v[6:7]
    v_pk_mul_f32 v[20:21], v[92:93], v[6:7]
    v_pk_mul_f32 v[22:23], v[94:95], v[6:7]
    ds_read_b128 v[80:83], v166 offset:13312
    ds_read_b128 v[84:87], v166 offset:14336
    ds_read_b128 v[88:91], v166 offset:15360
    ds_read_b128 v[92:95], v166 offset:16384
    v_pk_mul_f32 v[96:97], v[96:97], v[6:7]
    v_pk_mul_f32 v[98:99], v[98:99], v[6:7]
    ds_write_b128 v166, v[96:99]
    v_pk_mul_f32 v[100:101], v[100:101], v[6:7]
    v_pk_mul_f32 v[102:103], v[102:103], v[6:7]
    ds_write_b128 v166, v[100:103] offset:1024
    v_pk_mul_f32 v[104:105], v[104:105], v[6:7]
    v_pk_mul_f32 v[106:107], v[106:107], v[6:7]
    ds_write_b128 v166, v[104:107] offset:2048
    v_pk_mul_f32 v[108:109], v[108:109], v[6:7]
    v_pk_mul_f32 v[110:111], v[110:111], v[6:7]
    ds_write_b128 v166, v[108:111] offset:3072
    v_pk_mul_f32 v[112:113], v[112:113], v[6:7]
    v_pk_mul_f32 v[114:115], v[114:115], v[6:7]
    ds_write_b128 v166, v[112:115] offset:4096
    v_pk_mul_f32 v[116:117], v[116:117], v[6:7]
    v_pk_mul_f32 v[118:119], v[118:119], v[6:7]
    ds_write_b128 v166, v[116:119] offset:5120
    v_pk_mul_f32 v[120:121], v[120:121], v[6:7]
    v_pk_mul_f32 v[122:123], v[122:123], v[6:7]
    ds_write_b128 v166, v[120:123] offset:6144
    v_pk_mul_f32 v[124:125], v[124:125], v[6:7]
    v_pk_mul_f32 v[126:127], v[126:127], v[6:7]
    ds_write_b128 v166, v[124:127] offset:7168
    v_pk_mul_f32 v[128:129], v[128:129], v[6:7]
    v_pk_mul_f32 v[130:131], v[130:131], v[6:7]
    ds_write_b128 v166, v[128:131] offset:8192
    v_pk_mul_f32 v[132:133], v[132:133], v[6:7]
    v_pk_mul_f32 v[134:135], v[134:135], v[6:7]
    ds_write_b128 v166, v[132:135] offset:9216
    v_pk_mul_f32 v[136:137], v[136:137], v[6:7]
    v_pk_mul_f32 v[138:139], v[138:139], v[6:7]
    ds_write_b128 v166, v[136:139] offset:10240
    v_pk_mul_f32 v[140:141], v[140:141], v[6:7]
    v_pk_mul_f32 v[142:143], v[142:143], v[6:7]
    ds_write_b128 v166, v[140:143] offset:11264
    v_pk_mul_f32 v[144:145], v[144:145], v[6:7]
    v_pk_mul_f32 v[146:147], v[146:147], v[6:7]
    ds_write_b128 v166, v[144:147] offset:12288
    v_pk_mul_f32 v[148:149], v[148:149], v[6:7]
    v_pk_mul_f32 v[150:151], v[150:151], v[6:7]
    ds_write_b128 v166, v[148:151] offset:13312
    v_pk_mul_f32 v[152:153], v[152:153], v[6:7]
    v_pk_mul_f32 v[154:155], v[154:155], v[6:7]
    ds_write_b128 v166, v[152:155] offset:14336
    v_pk_mul_f32 v[156:157], v[156:157], v[6:7]
    v_pk_mul_f32 v[158:159], v[158:159], v[6:7]
    ds_write_b128 v166, v[156:159] offset:15360
    s_branch L_aux_rd
L_aux_r1:
    s_cmp_eq_u32 s40, 1
    s_cbranch_scc0 L_aux_r2
    s_nop 7
    v_pk_mul_f32 v[80:81], v[80:81], v[6:7]
    v_pk_mul_f32 v[82:83], v[82:83], v[6:7]
    ds_write_b128 v166, v[80:83]
    v_pk_mul_f32 v[84:85], v[84:85], v[6:7]
    v_pk_mul_f32 v[86:87], v[86:87], v[6:7]
    ds_write_b128 v166, v[84:87] offset:1024
    v_pk_mul_f32 v[88:89], v[88:89], v[6:7]
    v_pk_mul_f32 v[90:91], v[90:91], v[6:7]
    ds_write_b128 v166, v[88:91] offset:2048
    v_pk_mul_f32 v[92:93], v[92:93], v[6:7]
    v_pk_mul_f32 v[94:95], v[94:95], v[6:7]
    ds_write_b128 v166, v[92:95] offset:3072
    ds_read_b128 v[80:83], v166 offset:13312
    ds_read_b128 v[84:87], v166 offset:14336
    ds_read_b128 v[88:91], v166 offset:15360
    ds_read_b128 v[92:95], v166 offset:16384
    v_pk_mul_f32 v[8:9], v[96:97], v[6:7]
    v_pk_mul_f32 v[10:11], v[98:99], v[6:7]
    v_pk_mul_f32 v[12:13], v[100:101], v[6:7]
    v_pk_mul_f32 v[14:15], v[102:103], v[6:7]
    v_pk_mul_f32 v[16:17], v[104:105], v[6:7]
    v_pk_mul_f32 v[18:19], v[106:107], v[6:7]
    v_pk_mul_f32 v[20:21], v[108:109], v[6:7]
    v_pk_mul_f32 v[22:23], v[110:111], v[6:7]
    v_pk_mul_f32 v[112:113], v[112:113], v[6:7]
    v_pk_mul_f32 v[114:115], v[114:115], v[6:7]
    ds_write_b128 v166, v[112:115] offset:4096
    v_pk_mul_f32 v[116:117], v[116:117], v[6:7]
    v_pk_mul_f32 v[118:119], v[118:119], v[6:7]
    ds_write_b128 v166, v[116:119] offset:5120
    v_pk_mul_f32 v[120:121], v[120:121], v[6:7]
    v_pk_mul_f32 v[122:123], v[122:123], v[6:7]
    ds_write_b128 v166, v[120:123] offset:6144
    v_pk_mul_f32 v[124:125], v[124:125], v[6:7]
    v_pk_mul_f32 v[126:127], v[126:127], v[6:7]
    ds_write_b128 v166, v[124:127] offset:7168
    v_pk_mul_f32 v[128:129], v[128:129], v[6:7]
    v_pk_mul_f32 v[130:131], v[130:131], v[6:7]
    ds_write_b128 v166, v[128:131] offset:8192
    v_pk_mul_f32 v[132:133], v[132:133], v[6:7]
    v_pk_mul_f32 v[134:135], v[134:135], v[6:7]
    ds_write_b128 v166, v[132:135] offset:9216
    v_pk_mul_f32 v[136:137], v[136:137], v[6:7]
    v_pk_mul_f32 v[138:139], v[138:139], v[6:7]
    ds_write_b128 v166, v[136:139] offset:10240
    v_pk_mul_f32 v[140:141], v[140:141], v[6:7]
    v_pk_mul_f32 v[142:143], v[142:143], v[6:7]
    ds_write_b128 v166, v[140:143] offset:11264
    v_pk_mul_f32 v[144:145], v[144:145], v[6:7]
    v_pk_mul_f32 v[146:147], v[146:147], v[6:7]
    ds_write_b128 v166, v[144:147] offset:12288
    v_pk_mul_f32 v[148:149], v[148:149], v[6:7]
    v_pk_mul_f32 v[150:151], v[150:151], v[6:7]
    ds_write_b128 v166, v[148:151] offset:13312
    v_pk_mul_f32 v[152:153], v[152:153], v[6:7]
    v_pk_mul_f32 v[154:155], v[154:155], v[6:7]
    ds_write_b128 v166, v[152:155] offset:14336
    v_pk_mul_f32 v[156:157], v[156:157], v[6:7]
    v_pk_mul_f32 v[158:159], v[158:159], v[6:7]
    ds_write_b128 v166, v[156:159] offset:15360
    s_branch L_aux_rd
L_aux_r2:
    s_cmp_eq_u32 s40, 2
    s_cbranch_scc0 L_aux_r3
    s_nop 7
    v_pk_mul_f32 v[80:81], v[80:81], v[6:7]
    v_pk_mul_f32 v[82:83], v[82:83], v[6:7]
    ds_write_b128 v166, v[80:83]
    v_pk_mul_f32 v[84:85], v[84:85], v[6:7]
    v_pk_mul_f32 v[86:87], v[86:87], v[6:7]
    ds_write_b128 v166, v[84:87] offset:1024
    v_pk_mul_f32 v[88:89], v[88:89], v[6:7]
    v_pk_mul_f32 v[90:91], v[90:91], v[6:7]
    ds_write_b128 v166, v[88:91] offset:2048
    v_pk_mul_f32 v[92:93], v[92:93], v[6:7]
    v_pk_mul_f32 v[94:95], v[94:95], v[6:7]
    ds_write_b128 v166, v[92:95] offset:3072
    ds_read_b128 v[80:83], v166 offset:13312
    ds_read_b128 v[84:87], v166 offset:14336
    ds_read_b128 v[88:91], v166 offset:15360
    ds_read_b128 v[92:95], v166 offset:16384
    v_pk_mul_f32 v[96:97], v[96:97], v[6:7]
    v_pk_mul_f32 v[98:99], v[98:99], v[6:7]
    ds_write_b128 v166, v[96:99] offset:4096
    v_pk_mul_f32 v[100:101], v[100:101], v[6:7]
    v_pk_mul_f32 v[102:103], v[102:103], v[6:7]
    ds_write_b128 v166, v[100:103] offset:5120
    v_pk_mul_f32 v[104:105], v[104:105], v[6:7]
    v_pk_mul_f32 v[106:107], v[106:107], v[6:7]
    ds_write_b128 v166, v[104:107] offset:6144
    v_pk_mul_f32 v[108:109], v[108:109], v[6:7]
    v_pk_mul_f32 v[110:111], v[110:111], v[6:7]
    ds_write_b128 v166, v[108:111] offset:7168
    v_pk_mul_f32 v[8:9], v[112:113], v[6:7]
    v_pk_mul_f32 v[10:11], v[114:115], v[6:7]
    v_pk_mul_f32 v[12:13], v[116:117], v[6:7]
    v_pk_mul_f32 v[14:15], v[118:119], v[6:7]
    v_pk_mul_f32 v[16:17], v[120:121], v[6:7]
    v_pk_mul_f32 v[18:19], v[122:123], v[6:7]
    v_pk_mul_f32 v[20:21], v[124:125], v[6:7]
    v_pk_mul_f32 v[22:23], v[126:127], v[6:7]
    v_pk_mul_f32 v[128:129], v[128:129], v[6:7]
    v_pk_mul_f32 v[130:131], v[130:131], v[6:7]
    ds_write_b128 v166, v[128:131] offset:8192
    v_pk_mul_f32 v[132:133], v[132:133], v[6:7]
    v_pk_mul_f32 v[134:135], v[134:135], v[6:7]
    ds_write_b128 v166, v[132:135] offset:9216
    v_pk_mul_f32 v[136:137], v[136:137], v[6:7]
    v_pk_mul_f32 v[138:139], v[138:139], v[6:7]
    ds_write_b128 v166, v[136:139] offset:10240
    v_pk_mul_f32 v[140:141], v[140:141], v[6:7]
    v_pk_mul_f32 v[142:143], v[142:143], v[6:7]
    ds_write_b128 v166, v[140:143] offset:11264
    v_pk_mul_f32 v[144:145], v[144:145], v[6:7]
    v_pk_mul_f32 v[146:147], v[146:147], v[6:7]
    ds_write_b128 v166, v[144:147] offset:12288
    v_pk_mul_f32 v[148:149], v[148:149], v[6:7]
    v_pk_mul_f32 v[150:151], v[150:151], v[6:7]
    ds_write_b128 v166, v[148:151] offset:13312
    v_pk_mul_f32 v[152:153], v[152:153], v[6:7]
    v_pk_mul_f32 v[154:155], v[154:155], v[6:7]
    ds_write_b128 v166, v[152:155] offset:14336
    v_pk_mul_f32 v[156:157], v[156:157], v[6:7]
    v_pk_mul_f32 v[158:159], v[158:159], v[6:7]
    ds_write_b128 v166, v[156:159] offset:15360
    s_branch L_aux_rd
L_aux_r3:
    s_nop 7
    v_pk_mul_f32 v[80:81], v[80:81], v[6:7]
    v_pk_mul_f32 v[82:83], v[82:83], v[6:7]
    ds_write_b128 v166, v[80:83]
    v_pk_mul_f32 v[84:85], v[84:85], v[6:7]
    v_pk_mul_f32 v[86:87], v[86:87], v[6:7]
    ds_write_b128 v166, v[84:87] offset:1024
    v_pk_mul_f32 v[88:89], v[88:89], v[6:7]
    v_pk_mul_f32 v[90:91], v[90:91], v[6:7]
    ds_write_b128 v166, v[88:91] offset:2048
    v_pk_mul_f32 v[92:93], v[92:93], v[6:7]
    v_pk_mul_f32 v[94:95], v[94:95], v[6:7]
    ds_write_b128 v166, v[92:95] offset:3072
    ds_read_b128 v[80:83], v166 offset:13312
    ds_read_b128 v[84:87], v166 offset:14336
    ds_read_b128 v[88:91], v166 offset:15360
    ds_read_b128 v[92:95], v166 offset:16384
    v_pk_mul_f32 v[96:97], v[96:97], v[6:7]
    v_pk_mul_f32 v[98:99], v[98:99], v[6:7]
    ds_write_b128 v166, v[96:99] offset:4096
    v_pk_mul_f32 v[100:101], v[100:101], v[6:7]
    v_pk_mul_f32 v[102:103], v[102:103], v[6:7]
    ds_write_b128 v166, v[100:103] offset:5120
    v_pk_mul_f32 v[104:105], v[104:105], v[6:7]
    v_pk_mul_f32 v[106:107], v[106:107], v[6:7]
    ds_write_b128 v166, v[104:107] offset:6144
    v_pk_mul_f32 v[108:109], v[108:109], v[6:7]
    v_pk_mul_f32 v[110:111], v[110:111], v[6:7]
    ds_write_b128 v166, v[108:111] offset:7168
    v_pk_mul_f32 v[112:113], v[112:113], v[6:7]
    v_pk_mul_f32 v[114:115], v[114:115], v[6:7]
    ds_write_b128 v166, v[112:115] offset:8192
    v_pk_mul_f32 v[116:117], v[116:117], v[6:7]
    v_pk_mul_f32 v[118:119], v[118:119], v[6:7]
    ds_write_b128 v166, v[116:119] offset:9216
    v_pk_mul_f32 v[120:121], v[120:121], v[6:7]
    v_pk_mul_f32 v[122:123], v[122:123], v[6:7]
    ds_write_b128 v166, v[120:123] offset:10240
    v_pk_mul_f32 v[124:125], v[124:125], v[6:7]
    v_pk_mul_f32 v[126:127], v[126:127], v[6:7]
    ds_write_b128 v166, v[124:127] offset:11264
    v_pk_mul_f32 v[8:9], v[128:129], v[6:7]
    v_pk_mul_f32 v[10:11], v[130:131], v[6:7]
    v_pk_mul_f32 v[12:13], v[132:133], v[6:7]
    v_pk_mul_f32 v[14:15], v[134:135], v[6:7]
    v_pk_mul_f32 v[16:17], v[136:137], v[6:7]
    v_pk_mul_f32 v[18:19], v[138:139], v[6:7]
    v_pk_mul_f32 v[20:21], v[140:141], v[6:7]
    v_pk_mul_f32 v[22:23], v[142:143], v[6:7]
    v_pk_mul_f32 v[144:145], v[144:145], v[6:7]
    v_pk_mul_f32 v[146:147], v[146:147], v[6:7]
    ds_write_b128 v166, v[144:147] offset:12288
    v_pk_mul_f32 v[148:149], v[148:149], v[6:7]
    v_pk_mul_f32 v[150:151], v[150:151], v[6:7]
    ds_write_b128 v166, v[148:151] offset:13312
    v_pk_mul_f32 v[152:153], v[152:153], v[6:7]
    v_pk_mul_f32 v[154:155], v[154:155], v[6:7]
    ds_write_b128 v166, v[152:155] offset:14336
    v_pk_mul_f32 v[156:157], v[156:157], v[6:7]
    v_pk_mul_f32 v[158:159], v[158:159], v[6:7]
    ds_write_b128 v166, v[156:159] offset:15360
L_aux_rd:
    s_waitcnt lgkmcnt(0)
    s_barrier
    buffer_load_dwordx4 v[96:99], v1, s[8:11], s39 offen sc1
    s_add_u32 s39, s39, 5120
    buffer_load_dwordx4 v[100:103], v1, s[8:11], s39 offen sc1
    s_add_u32 s39, s39, 5120
    buffer_load_dwordx4 v[104:107], v1, s[8:11], s39 offen sc1
    s_add_u32 s39, s39, 5120
    buffer_load_dwordx4 v[108:111], v1, s[8:11], s39 offen sc1
    s_add_u32 s39, s39, 5120
    s_barrier
    ds_read_b128 v[4:7], v165
    ds_read_b128 v[24:27], v165 offset:1024
    ds_read_b128 v[156:159], v165 offset:2048
    ds_read_b128 v[160:163], v165 offset:3072
    buffer_load_dwordx4 v[112:115], v1, s[8:11], s39 offen sc1
    s_add_u32 s39, s39, 5120
    buffer_load_dwordx4 v[116:119], v1, s[8:11], s39 offen sc1
    s_add_u32 s39, s39, 5120
    buffer_load_dwordx4 v[120:123], v1, s[8:11], s39 offen sc1
    s_add_u32 s39, s39, 5120
    buffer_load_dwordx4 v[124:127], v1, s[8:11], s39 offen sc1
    s_add_u32 s39, s39, 5120
    buffer_load_dwordx4 v[128:131], v1, s[8:11], s39 offen sc1
    s_add_u32 s39, s39, 5120
    buffer_load_dwordx4 v[132:135], v1, s[8:11], s39 offen sc1
    s_add_u32 s39, s39, 5120
    buffer_load_dwordx4 v[136:139], v1, s[8:11], s39 offen sc1
    s_add_u32 s39, s39, 5120
    buffer_load_dwordx4 v[140:143], v1, s[8:11], s39 offen sc1
    s_add_u32 s39, s39, 5120
    buffer_load_dwordx4 v[144:147], v1, s[8:11], s39 offen sc1
    s_add_u32 s39, s39, 5120
    buffer_load_dwordx4 v[148:151], v1, s[8:11], s39 offen sc1
    s_add_u32 s39, s39, 5120
    buffer_load_dwordx4 v[152:155], v1, s[8:11], s39 offen sc1
    s_waitcnt lgkmcnt(3)
    v_mfma_f32_32x32x16_bf16 v[8:23], v[28:31], v[4:7], v[8:23]
    ds_read_b128 v[4:7], v165 offset:4096
    s_waitcnt lgkmcnt(3)
    v_mfma_f32_32x32x16_bf16 v[8:23], v[32:35], v[24:27], v[8:23]
    ds_read_b128 v[28:31], v165 offset:5120
    s_waitcnt lgkmcnt(3)
    v_mfma_f32_32x32x16_bf16 v[8:23], v[36:39], v[156:159], v[8:23]
    ds_read_b128 v[32:35], v165 offset:6144
    s_waitcnt lgkmcnt(3)
    v_mfma_f32_32x32x16_bf16 v[8:23], v[40:43], v[160:163], v[8:23]
    ds_read_b128 v[36:39], v165 offset:7168
    s_waitcnt lgkmcnt(3)
    v_mfma_f32_32x32x16_bf16 v[8:23], v[44:47], v[4:7], v[8:23]
    ds_read_b128 v[40:43], v165 offset:8192
    s_waitcnt lgkmcnt(3)
    v_mfma_f32_32x32x16_bf16 v[8:23], v[48:51], v[28:31], v[8:23]
    ds_read_b128 v[44:47], v165 offset:9216
    s_waitcnt lgkmcnt(3)
    v_mfma_f32_32x32x16_bf16 v[8:23], v[52:55], v[32:35], v[8:23]
    ds_read_b128 v[48:51], v165 offset:10240
    s_waitcnt lgkmcnt(3)
    v_mfma_f32_32x32x16_bf16 v[8:23], v[56:59], v[36:39], v[8:23]
    ds_read_b128 v[52:55], v165 offset:11264
    s_waitcnt lgkmcnt(3)
    v_mfma_f32_32x32x16_bf16 v[8:23], v[60:63], v[40:43], v[8:23]
    ds_read_b128 v[56:59], v165 offset:12288
    s_waitcnt lgkmcnt(3)
    v_mfma_f32_32x32x16_bf16 v[8:23], v[64:67], v[44:47], v[8:23]
    ds_read_b128 v[60:63], v165 offset:13312
    s_waitcnt lgkmcnt(3)
    v_mfma_f32_32x32x16_bf16 v[8:23], v[68:71], v[48:51], v[8:23]
    ds_read_b128 v[64:67], v165 offset:14336
    s_waitcnt lgkmcnt(3)
    v_mfma_f32_32x32x16_bf16 v[8:23], v[72:75], v[52:55], v[8:23]
    ds_read_b128 v[68:71], v165 offset:15360
    s_waitcnt lgkmcnt(3)
    v_mfma_f32_32x32x16_bf16 v[8:23], v[76:79], v[56:59], v[8:23]
    ds_read_b128 v[72:75], v165 offset:16384
    s_waitcnt lgkmcnt(3)
    v_mfma_f32_32x32x16_bf16 v[8:23], v[80:83], v[60:63], v[8:23]
    ds_read_b128 v[76:79], v165 offset:17408
    s_waitcnt lgkmcnt(3)
    v_mfma_f32_32x32x16_bf16 v[8:23], v[84:87], v[64:67], v[8:23]
    ds_read_b128 v[80:83], v165 offset:18432
    s_waitcnt lgkmcnt(3)
    v_mfma_f32_32x32x16_bf16 v[8:23], v[88:91], v[68:71], v[8:23]
    ds_read_b128 v[84:87], v165 offset:19456
    s_barrier
    ds_read_b128 v[28:31], v3
    ds_read_b128 v[32:35], v3 offset:1024
    ds_read_b128 v[36:39], v3 offset:2048
    ds_read_b128 v[40:43], v3 offset:3072
    s_waitcnt lgkmcnt(7)
    v_mfma_f32_32x32x16_bf16 v[8:23], v[92:95], v[72:75], v[8:23]
    ds_read_b128 v[88:91], v165 offset:20480
    s_waitcnt vmcnt(14) lgkmcnt(7)
    v_mfma_f32_32x32x16_bf16 v[8:23], v[96:99], v[76:79], v[8:23]
    ds_read_b128 v[92:95], v165 offset:21504
    s_waitcnt vmcnt(13) lgkmcnt(7)
    v_mfma_f32_32x32x16_bf16 v[8:23], v[100:103], v[80:83], v[8:23]
    ds_read_b128 v[96:99], v165 offset:22528
    s_waitcnt vmcnt(12) lgkmcnt(7)
    v_mfma_f32_32x32x16_bf16 v[8:23], v[104:107], v[84:87], v[8:23]
    ds_read_b128 v[100:103], v165 offset:23552
    s_waitcnt vmcnt(11) lgkmcnt(3)
    v_mfma_f32_32x32x16_bf16 v[8:23], v[108:111], v[88:91], v[8:23]
    ds_read_b128 v[104:107], v165 offset:24576
    s_waitcnt vmcnt(10) lgkmcnt(3)
    v_mfma_f32_32x32x16_bf16 v[8:23], v[112:115], v[92:95], v[8:23]
    ds_read_b128 v[108:111], v165 offset:25600
    s_waitcnt vmcnt(9) lgkmcnt(3)
    v_mfma_f32_32x32x16_bf16 v[8:23], v[116:119], v[96:99], v[8:23]
    ds_read_b128 v[112:115], v165 offset:26624
    s_waitcnt vmcnt(8) lgkmcnt(3)
    v_mfma_f32_32x32x16_bf16 v[8:23], v[120:123], v[100:103], v[8:23]
    ds_read_b128 v[116:119], v165 offset:27648
    s_waitcnt vmcnt(7) lgkmcnt(3)
    v_mfma_f32_32x32x16_bf16 v[8:23], v[124:127], v[104:107], v[8:23]
    ds_read_b128 v[120:123], v165 offset:28672
    s_waitcnt vmcnt(6) lgkmcnt(3)
    v_mfma_f32_32x32x16_bf16 v[8:23], v[128:131], v[108:111], v[8:23]
    ds_read_b128 v[124:127], v165 offset:29696
    s_waitcnt vmcnt(5) lgkmcnt(3)
    v_mfma_f32_32x32x16_bf16 v[8:23], v[132:135], v[112:115], v[8:23]
    ds_read_b128 v[128:131], v165 offset:30720
    s_waitcnt vmcnt(4) lgkmcnt(3)
    v_mfma_f32_32x32x16_bf16 v[8:23], v[136:139], v[116:119], v[8:23]
    ds_read_b128 v[132:135], v165 offset:31744
    s_waitcnt vmcnt(3) lgkmcnt(3)
    v_mfma_f32_32x32x16_bf16 v[8:23], v[140:143], v[120:123], v[8:23]
    s_waitcnt vmcnt(2) lgkmcnt(2)
    v_mfma_f32_32x32x16_bf16 v[8:23], v[144:147], v[124:127], v[8:23]
    s_waitcnt vmcnt(1) lgkmcnt(1)
    v_mfma_f32_32x32x16_bf16 v[8:23], v[148:151], v[128:131], v[8:23]
    s_waitcnt vmcnt(0) lgkmcnt(0)
    v_mfma_f32_32x32x16_bf16 v[8:23], v[152:155], v[132:135], v[8:23]
    s_nop 11
    v_pk_add_f32 v[8:9], v[8:9], v[28:29]
    v_pk_add_f32 v[10:11], v[10:11], v[30:31]
    v_pk_add_f32 v[12:13], v[12:13], v[32:33]
    v_pk_add_f32 v[14:15], v[14:15], v[34:35]
    v_cvt_pk_bf16_f32 v44, v8, v9
    v_cvt_pk_bf16_f32 v45, v10, v11
    v_cvt_pk_bf16_f32 v46, v12, v13
    v_cvt_pk_bf16_f32 v47, v14, v15
    v_pk_add_f32 v[16:17], v[16:17], v[36:37]
    v_pk_add_f32 v[18:19], v[18:19], v[38:39]
    v_pk_add_f32 v[20:21], v[20:21], v[40:41]
    v_pk_add_f32 v[22:23], v[22:23], v[42:43]
    v_cvt_pk_bf16_f32 v48, v16, v17
    v_cvt_pk_bf16_f32 v49, v18, v19
    v_cvt_pk_bf16_f32 v50, v20, v21
    v_cvt_pk_bf16_f32 v51, v22, v23
    v_permlane32_swap_b32 v44, v46
    v_permlane32_swap_b32 v45, v47
    v_permlane32_swap_b32 v48, v50
    v_permlane32_swap_b32 v49, v51
    s_nop 0
    buffer_store_dwordx4 v[44:47], v164, s[32:35], 0 offen
    buffer_store_dwordx4 v[48:51], v164, s[32:35], 0 offen offset:32
    s_branch L_end
L_comp:
    s_lshr_b32 s15, s12, 2
    s_and_b32 s16, s12, 3
    s_sub_u32 s29, s20, 27
    s_lshl_b32 s29, s29, 3
    s_add_u32 s29, s29, s14
    s_mov_b32 s60, -1
    s_mov_b32 s61, 0
    s_lshl_b32 s28, s14, 3
    s_lshl_b32 s24, s16, 1
    s_add_u32 s28, s28, s24
    v_lshlrev_b32 v1, 4, v0
    s_waitcnt lgkmcnt(0)
    s_mov_b32 s8, s84
    s_mov_b32 s9, s85
    s_mov_b32 s10, 0x2000000
    s_mov_b32 s11, 0x00020000
    s_mov_b32 s48, s64
    s_mov_b32 s49, s65
    s_mov_b32 s50, 0x280000
    s_mov_b32 s51, 0x00020000
    s_mov_b32 s56, s82
    s_mov_b32 s57, s83
    s_mov_b32 s58, 0x100
    s_mov_b32 s59, 0x00020000
    v_mov_b32 v13, 0
    s_cmp_eq_u32 s12, 0
    s_cbranch_scc0 L_nz
L_nz:
    v_and_b32 v20, 31, v0
    v_lshrrev_b32 v21, 5, v0
    v_bfe_u32 v22, v0, 2, 2
    v_and_b32 v23, 3, v0
    v_bfe_u32 v24, v0, 4, 1
    v_and_b32 v34, 15, v0
    v_lshrrev_b32 v35, 4, v0
    v_lshrrev_b32 v25, 1, v34
    v_xor_b32 v25, v25, v35
    v_lshlrev_b32 v25, 4, v25
    s_lshl_b32 s24, s16, 13
    v_lshl_add_u32 v26, v34, 7, s24
    v_add_u32 v160, v26, v25
    v_xor_b32 v161, 64, v160
    v_lshlrev_b32 v28, 10, v35
    v_lshl_add_u32 v28, v22, 7, v28
    v_and_b32 v29, 1, v23
    v_lshl_add_u32 v28, v29, 3, v28
    v_add_u32 v28, 98304, v28
    v_lshrrev_b32 v29, 1, v23
    v_and_b32 v30, 2, v22
    v_xor_b32 v29, v29, v30
    v_lshlrev_b32 v30, 2, v24
    v_xor_b32 v29, v29, v30
    v_lshlrev_b32 v8, 4, v34
    v_lshl_add_u32 v8, v24, 9, v8
    v_lshl_add_u32 v8, v21, 3, v8
    v_mov_b32 v2, v1
    v_lshlrev_b32 v30, 3, v20
    v_add_u32 v3, 2432, v30
    v_mov_b32 v31, 1344
    v_cndmask_b32 v3, v31, v3, s[60:61]
    s_mul_i32 s24, s15, 10752
    s_add_u32 s24, s24, 1024
    v_min_u32 v31, 21, v20
    v_lshlrev_b32 v31, 4, v31
    v_mul_u32_u24 v32, 352, v21
    v_add3_u32 v4, v31, v32, s24
    v_mov_b32 v5, 0xdddddddd
    s_mul_i32 s24, s16, 5376
    v_add_u32 v6, s24, v1
    v_add_u32 v30, s24, v30
    s_mov_b32 s88, 12800
    s_mov_b32 s89, 0xffff3800
    s_mov_b32 s90, 32768
    s_mov_b32 s91, 0xffff0000
    s_mov_b32 s21, 0
    s_mov_b32 s62, 0
    s_mov_b32 s63, 0
    s_cmp_eq_u32 s15, 0
    s_cbranch_scc0 L_B
    v_add_u32 v7, 50176, v30
    v_add_u32 v12, s24, v8
    v_lshl_add_u32 v30, v34, 3, s24
    v_mul_u32_u24 v31, 47744, v24
    v_sub_u32 v30, v30, v31
    v_add_u32 v13, 50176, v30
    v_lshrrev_b32 v30, 3, v34
    v_mul_u32_u24 v30, 352, v30
    v_and_b32 v32, 7, v34
    v_lshl_add_u32 v30, v32, 1, v30
    v_lshl_add_u32 v30, v35, 6, v30
    s_add_u32 s24, s24, 896
    v_add_u32 v14, s24, v30
    v_mov_b32 v9, 0x3f80
    v_mov_b32 v30, 0x3ea52b5c
    v_cmp_gt_u32 vcc, 16, v0
    v_lshlrev_b32 v31, 9, v35
    v_cndmask_b32 v10, 1.0, v30, vcc
    v_lshl_add_u32 v30, v22, 6, v31
    v_lshl_add_u32 v30, v24, 5, v30
    v_lshl_add_u32 v30, v23, 3, v30
    v_add_u32 v164, 106496, v30
    v_xor_b32 v162, 32, v164
    v_lshl_add_u32 v30, v35, 3, v22
    v_mul_u32_u24 v30, 80, v30
    v_add_u32 v30, 108544, v30
    v_mov_b32 v31, 0x28201000
    v_mov_b32 v32, 0x48483830
    v_lshlrev_b32 v33, 3, v23
    v_bfe_u32 v31, v31, v33, 8
    v_bfe_u32 v32, v32, v33, 8
    v_add_u32 v165, v30, v31
    v_add_u32 v163, v30, v32
    v_xor_b32 v166, 0, v29
    v_lshl_add_u32 v166, v166, 4, v28
    v_mov_b64 v[64:65], 0
    v_mov_b64 v[66:67], 0
    v_mov_b64 v[68:69], 0
    v_mov_b64 v[70:71], 0
    v_mov_b64 v[72:73], 0
    v_mov_b64 v[74:75], 0
    v_mov_b64 v[76:77], 0
    v_mov_b64 v[78:79], 0
    v_mov_b64 v[80:81], 0
    v_mov_b64 v[82:83], 0
    v_mov_b64 v[84:85], 0
    v_mov_b64 v[86:87], 0
    v_mov_b64 v[88:89], 0
    v_mov_b64 v[90:91], 0
    v_mov_b64 v[92:93], 0
    v_mov_b64 v[94:95], 0
    v_mov_b64 v[96:97], 0
    v_mov_b64 v[98:99], 0
    v_mov_b64 v[100:101], 0
    v_mov_b64 v[102:103], 0
    v_mov_b64 v[104:105], 0
    v_mov_b64 v[106:107], 0
    v_mov_b64 v[108:109], 0
    v_mov_b64 v[110:111], 0
    v_mov_b64 v[112:113], 0
    v_mov_b64 v[114:115], 0
    v_mov_b64 v[116:117], 0
    v_mov_b64 v[118:119], 0
    v_mov_b64 v[120:121], 0
    v_mov_b64 v[122:123], 0
    v_mov_b64 v[124:125], 0
    v_mov_b64 v[126:127], 0
    v_mov_b64 v[128:129], 0
    v_mov_b64 v[130:131], 0
    v_mov_b64 v[132:133], 0
    v_mov_b64 v[134:135], 0
    v_mov_b64 v[136:137], 0
    v_mov_b64 v[138:139], 0
    v_mov_b64 v[140:141], 0
    v_mov_b64 v[142:143], 0
    v_mov_b64 v[144:145], 0
    v_mov_b64 v[146:147], 0
    v_mov_b64 v[148:149], 0
    v_mov_b64 v[150:151], 0
    v_mov_b64 v[152:153], 0
    v_mov_b64 v[154:155], 0
    v_mov_b64 v[156:157], 0
    v_mov_b64 v[158:159], 0
    s_cmp_eq_u32 s12, 0
    s_cbranch_scc0 L_ncnt
L_ncnt:
    s_barrier
    s_cmp_lt_u32 s20, 27
    s_cbranch_scc0 L_A_short
    ds_read_b64_tr_b16 v[40:41], v164
    ds_read_b64_tr_b16 v[42:43], v164 offset:256
    ds_read_b64_tr_b16 v[44:45], v162
    ds_read_b64_tr_b16 v[46:47], v162 offset:256
    ds_read_b128 v[24:27], v160
    ds_read_b64_tr_b16 v[48:49], v165
    ds_read_b64_tr_b16 v[50:51], v165 offset:320
    ds_read_b128 v[28:31], v160 offset:2048
    ds_read_b128 v[32:35], v160 offset:4096
    ds_read_b128 v[36:39], v160 offset:6144
.p2align 6
L_g_A:
    s_waitcnt lgkmcnt(5)
    v_mfma_f32_16x16x32_bf16 v[64:67], v[40:43], v[24:27], v[64:67]
    ds_read_b64_tr_b16 v[52:53], v163
    ds_read_b64_tr_b16 v[54:55], v163 offset:320
    v_mfma_f32_16x16x32_bf16 v[72:75], v[44:47], v[24:27], v[72:75]
    ds_read_b64_tr_b16 v[56:57], v166
    ds_read_b64_tr_b16 v[58:59], v166 offset:512
    s_waitcnt lgkmcnt(7)
    v_mfma_f32_16x16x32_bf16 v[80:83], v[48:51], v[24:27], v[80:83]
    ds_read_b64_tr_b16 v[60:61], v166 offset:4096
    ds_read_b64_tr_b16 v[62:63], v166 offset:4608
    s_waitcnt lgkmcnt(8)
    v_mfma_f32_16x16x32_bf16 v[84:87], v[48:51], v[28:31], v[84:87]
    s_add_u32 s63, s63, 1
    s_cmp_eq_u32 s63, 5
    v_mfma_f32_16x16x32_bf16 v[76:79], v[44:47], v[28:31], v[76:79]
    s_cselect_b32 s87, s89, s88
    s_cselect_b32 s63, 0, s63
    v_mfma_f32_16x16x32_bf16 v[68:71], v[40:43], v[28:31], v[68:71]
    s_add_u32 s62, s62, 1
    s_cmp_eq_u32 s62, 3
    s_waitcnt lgkmcnt(7)
    v_mfma_f32_16x16x32_bf16 v[112:115], v[40:43], v[32:35], v[112:115]
    s_cselect_b32 s86, s91, s90
    s_cselect_b32 s62, 0, s62
    v_mfma_f32_16x16x32_bf16 v[120:123], v[44:47], v[32:35], v[120:123]
    v_add_u32 v162, s87, v162
    v_add_u32 v163, s87, v163
    v_mfma_f32_16x16x32_bf16 v[128:131], v[48:51], v[32:35], v[128:131]
    v_add_u32 v164, s87, v164
    v_add_u32 v165, s87, v165
    s_waitcnt lgkmcnt(6)
    v_mfma_f32_16x16x32_bf16 v[132:135], v[48:51], v[36:39], v[132:135]
    v_add_u32 v166, s87, v166
    v_add_u32 v160, s86, v160
    v_mfma_f32_16x16x32_bf16 v[124:127], v[44:47], v[36:39], v[124:127]
    v_mfma_f32_16x16x32_bf16 v[116:119], v[40:43], v[36:39], v[116:119]
    s_waitcnt lgkmcnt(0)
    s_barrier
    v_mfma_f32_16x16x32_bf16 v[88:91], v[52:55], v[24:27], v[88:91]
    ds_read_b64_tr_b16 v[40:41], v164
    ds_read_b64_tr_b16 v[42:43], v164 offset:256
    v_mfma_f32_16x16x32_bf16 v[96:99], v[56:59], v[24:27], v[96:99]
    ds_read_b64_tr_b16 v[44:45], v162
    ds_read_b64_tr_b16 v[46:47], v162 offset:256
    v_mfma_f32_16x16x32_bf16 v[104:107], v[60:63], v[24:27], v[104:107]
    ds_read_b128 v[24:27], v161
    v_mfma_f32_16x16x32_bf16 v[108:111], v[60:63], v[28:31], v[108:111]
    ds_read_b64_tr_b16 v[48:49], v165
    ds_read_b64_tr_b16 v[50:51], v165 offset:320
    v_mfma_f32_16x16x32_bf16 v[100:103], v[56:59], v[28:31], v[100:103]
    v_mfma_f32_16x16x32_bf16 v[92:95], v[52:55], v[28:31], v[92:95]
    ds_read_b128 v[28:31], v161 offset:2048
    v_mfma_f32_16x16x32_bf16 v[136:139], v[52:55], v[32:35], v[136:139]
    v_mfma_f32_16x16x32_bf16 v[144:147], v[56:59], v[32:35], v[144:147]
    v_mfma_f32_16x16x32_bf16 v[152:155], v[60:63], v[32:35], v[152:155]
    ds_read_b128 v[32:35], v161 offset:4096
    v_mfma_f32_16x16x32_bf16 v[156:159], v[60:63], v[36:39], v[156:159]
    v_mfma_f32_16x16x32_bf16 v[148:151], v[56:59], v[36:39], v[148:151]
    v_mfma_f32_16x16x32_bf16 v[140:143], v[52:55], v[36:39], v[140:143]
    ds_read_b128 v[36:39], v161 offset:6144
    s_waitcnt lgkmcnt(5)
    v_mfma_f32_16x16x32_bf16 v[64:67], v[40:43], v[24:27], v[64:67]
    ds_read_b64_tr_b16 v[52:53], v163
    ds_read_b64_tr_b16 v[54:55], v163 offset:320
    v_mfma_f32_16x16x32_bf16 v[72:75], v[44:47], v[24:27], v[72:75]
    ds_read_b64_tr_b16 v[56:57], v166
    ds_read_b64_tr_b16 v[58:59], v166 offset:512
    s_waitcnt lgkmcnt(7)
    v_mfma_f32_16x16x32_bf16 v[80:83], v[48:51], v[24:27], v[80:83]
    ds_read_b64_tr_b16 v[60:61], v166 offset:4096
    ds_read_b64_tr_b16 v[62:63], v166 offset:4608
    s_waitcnt lgkmcnt(8)
    v_mfma_f32_16x16x32_bf16 v[84:87], v[48:51], v[28:31], v[84:87]
    s_add_u32 s63, s63, 1
    s_cmp_eq_u32 s63, 5
    v_mfma_f32_16x16x32_bf16 v[76:79], v[44:47], v[28:31], v[76:79]
    s_cselect_b32 s87, s89, s88
    s_cselect_b32 s63, 0, s63
    v_mfma_f32_16x16x32_bf16 v[68:71], v[40:43], v[28:31], v[68:71]
    v_add_u32 v162, s87, v162
    v_add_u32 v163, s87, v163
    s_waitcnt lgkmcnt(7)
    v_mfma_f32_16x16x32_bf16 v[112:115], v[40:43], v[32:35], v[112:115]
    v_add_u32 v164, s87, v164
    v_add_u32 v165, s87, v165
    v_mfma_f32_16x16x32_bf16 v[120:123], v[44:47], v[32:35], v[120:123]
    v_add_u32 v166, s87, v166
    v_add_u32 v161, s86, v161
    v_mfma_f32_16x16x32_bf16 v[128:131], v[48:51], v[32:35], v[128:131]
    s_waitcnt lgkmcnt(6)
    v_mfma_f32_16x16x32_bf16 v[132:135], v[48:51], v[36:39], v[132:135]
    v_mfma_f32_16x16x32_bf16 v[124:127], v[44:47], v[36:39], v[124:127]
    v_mfma_f32_16x16x32_bf16 v[116:119], v[40:43], v[36:39], v[116:119]
    s_waitcnt lgkmcnt(0)
    s_barrier
    v_mfma_f32_16x16x32_bf16 v[88:91], v[52:55], v[24:27], v[88:91]
    ds_read_b64_tr_b16 v[40:41], v164
    ds_read_b64_tr_b16 v[42:43], v164 offset:256
    v_mfma_f32_16x16x32_bf16 v[96:99], v[56:59], v[24:27], v[96:99]
    ds_read_b64_tr_b16 v[44:45], v162
    ds_read_b64_tr_b16 v[46:47], v162 offset:256
    v_mfma_f32_16x16x32_bf16 v[104:107], v[60:63], v[24:27], v[104:107]
    ds_read_b128 v[24:27], v160
    v_mfma_f32_16x16x32_bf16 v[108:111], v[60:63], v[28:31], v[108:111]
    ds_read_b64_tr_b16 v[48:49], v165
    ds_read_b64_tr_b16 v[50:51], v165 offset:320
    v_mfma_f32_16x16x32_bf16 v[100:103], v[56:59], v[28:31], v[100:103]
    s_add_u32 s21, s21, 1
    v_mfma_f32_16x16x32_bf16 v[92:95], v[52:55], v[28:31], v[92:95]
    ds_read_b128 v[28:31], v160 offset:2048
    v_mfma_f32_16x16x32_bf16 v[136:139], v[52:55], v[32:35], v[136:139]
    s_cmp_lt_u32 s21, 10
    v_mfma_f32_16x16x32_bf16 v[144:147], v[56:59], v[32:35], v[144:147]
    v_mfma_f32_16x16x32_bf16 v[152:155], v[60:63], v[32:35], v[152:155]
    ds_read_b128 v[32:35], v160 offset:4096
    v_mfma_f32_16x16x32_bf16 v[156:159], v[60:63], v[36:39], v[156:159]
    v_mfma_f32_16x16x32_bf16 v[148:151], v[56:59], v[36:39], v[148:151]
    v_mfma_f32_16x16x32_bf16 v[140:143], v[52:55], v[36:39], v[140:143]
    ds_read_b128 v[36:39], v160 offset:6144
    s_cbranch_scc1 L_g_A
    s_waitcnt lgkmcnt(0)
    s_setprio 1
    s_mov_b32 s88, 0xbdd2d3e8
    s_mov_b32 s89, 0xbdd2d3e8
    s_mov_b32 s90, 1.0
    s_mov_b32 s91, 1.0
    v_mov_b32 v160, 0xc0135761
    v_mov_b32 v161, 0xc0135761
    s_lshl_b32 s24, s16, 13
    s_add_u32 s24, s24, 98304
    v_add_u32 v162, s24, v8
    s_nop 7
    s_mov_b32 s26, 0x3ea52b5c
    s_mov_b32 s27, 0x3ea52b5c
    s_mov_b32 s98, -1
    s_mov_b32 s99, 0xffff
    v_cvt_pk_bf16_f32 v24, v72, v73
    v_cvt_pk_bf16_f32 v25, v74, v75
    v_cvt_pk_bf16_f32 v26, v76, v77
    v_cvt_pk_bf16_f32 v27, v78, v79
    v_pk_mul_f32 v[80:81], v[80:81], v[10:11] op_sel_hi:[1,0]
    v_pk_mul_f32 v[82:83], v[82:83], v[10:11] op_sel_hi:[1,0]
    v_pk_mul_f32 v[84:85], v[84:85], v[10:11] op_sel_hi:[1,0]
    v_pk_mul_f32 v[86:87], v[86:87], v[10:11] op_sel_hi:[1,0]
    ds_write_b64 v12, v[24:25]
    ds_write_b64 v12, v[26:27] offset:256
    v_cvt_pk_bf16_f32 v28, v88, v89
    v_cvt_pk_bf16_f32 v29, v90, v91
    v_cvt_pk_bf16_f32 v30, v92, v93
    v_cvt_pk_bf16_f32 v31, v94, v95
    v_cvt_pk_bf16_f32 v32, v80, v81
    v_cvt_pk_bf16_f32 v33, v82, v83
    v_cvt_pk_bf16_f32 v34, v84, v85
    v_cvt_pk_bf16_f32 v35, v86, v87
    v_cndmask_b32 v28, v9, v28, s[98:99]
    v_cndmask_b32 v30, v9, v30, s[98:99]
    ds_write_b16 v14, v28 offset:256
    ds_write_b16_d16_hi v14, v28 offset:272
    ds_write_b16 v14, v30 offset:960
    ds_write_b16_d16_hi v14, v30 offset:976
    v_cvt_pk_bf16_f32 v36, v120, v121
    v_cvt_pk_bf16_f32 v37, v122, v123
    v_cvt_pk_bf16_f32 v38, v124, v125
    v_cvt_pk_bf16_f32 v39, v126, v127
    v_pk_mul_f32 v[128:129], v[128:129], v[10:11] op_sel_hi:[1,0]
    v_pk_mul_f32 v[130:131], v[130:131], v[10:11] op_sel_hi:[1,0]
    v_pk_mul_f32 v[132:133], v[132:133], v[10:11] op_sel_hi:[1,0]
    v_pk_mul_f32 v[134:135], v[134:135], v[10:11] op_sel_hi:[1,0]
    ds_write_b64 v12, v[36:37] offset:2688
    ds_write_b64 v12, v[38:39] offset:2944
    v_cvt_pk_bf16_f32 v40, v136, v137
    v_cvt_pk_bf16_f32 v41, v138, v139
    v_cvt_pk_bf16_f32 v42, v140, v141
    v_cvt_pk_bf16_f32 v43, v142, v143
    v_cvt_pk_bf16_f32 v44, v128, v129
    v_cvt_pk_bf16_f32 v45, v130, v131
    v_cvt_pk_bf16_f32 v46, v132, v133
    v_cvt_pk_bf16_f32 v47, v134, v135
    v_cndmask_b32 v40, v9, v40, s[98:99]
    v_cndmask_b32 v42, v9, v42, s[98:99]
    ds_write_b16 v14, v40 offset:2944
    ds_write_b16_d16_hi v14, v40 offset:2960
    ds_write_b16 v14, v42 offset:3648
    ds_write_b16_d16_hi v14, v42 offset:3664
    s_mov_b32 exec_hi, 0xffff
    ds_write_b16 v14, v29 offset:288
    ds_write_b16_d16_hi v14, v29 offset:304
    ds_write_b16 v14, v31 offset:992
    ds_write_b16_d16_hi v14, v31 offset:1008
    ds_write_b16 v14, v41 offset:2976
    ds_write_b16_d16_hi v14, v41 offset:2992
    ds_write_b16 v14, v43 offset:3680
    ds_write_b16_d16_hi v14, v43 offset:3696
    s_mov_b32 exec_hi, 0
    ds_write_b64 v13, v[32:33]
    ds_write_b64 v13, v[34:35] offset:128
    ds_write_b64 v13, v[44:45] offset:2688
    ds_write_b64 v13, v[46:47] offset:2816
    s_mov_b32 exec_lo, 0
    s_mov_b32 exec_hi, -1
    ds_write_b16 v14, v32
    ds_write_b16_d16_hi v14, v32 offset:16
    ds_write_b16 v14, v33 offset:32
    ds_write_b16_d16_hi v14, v33 offset:48
    ds_write_b16 v14, v34 offset:704
    ds_write_b16_d16_hi v14, v34 offset:720
    ds_write_b16 v14, v35 offset:736
    ds_write_b16_d16_hi v14, v35 offset:752
    ds_write_b16 v14, v44 offset:2688
    ds_write_b16_d16_hi v14, v44 offset:2704
    ds_write_b16 v14, v45 offset:2720
    ds_write_b16_d16_hi v14, v45 offset:2736
    ds_write_b16 v14, v46 offset:3392
    ds_write_b16_d16_hi v14, v46 offset:3408
    ds_write_b16 v14, v47 offset:3424
    ds_write_b16_d16_hi v14, v47 offset:3440
    s_mov_b32 exec_lo, -1
    v_pk_mul_f32 v[64:65], v[64:65], s[26:27]
    v_pk_mul_f32 v[66:67], v[66:67], s[26:27]
    v_pk_mul_f32 v[68:69], v[68:69], s[26:27]
    v_pk_mul_f32 v[70:71], v[70:71], s[26:27]
    v_cvt_pk_bf16_f32 v48, v64, v65
    v_cvt_pk_bf16_f32 v49, v66, v67
    v_cvt_pk_bf16_f32 v50, v68, v69
    v_cvt_pk_bf16_f32 v51, v70, v71
    ds_write_b64 v12, v[48:49] offset:49152
    ds_write_b64 v12, v[50:51] offset:49408
    v_pk_mul_f32 v[112:113], v[112:113], s[26:27]
    v_pk_mul_f32 v[114:115], v[114:115], s[26:27]
    v_pk_mul_f32 v[116:117], v[116:117], s[26:27]
    v_pk_mul_f32 v[118:119], v[118:119], s[26:27]
    v_cvt_pk_bf16_f32 v52, v112, v113
    v_cvt_pk_bf16_f32 v53, v114, v115
    v_cvt_pk_bf16_f32 v54, v116, v117
    v_cvt_pk_bf16_f32 v55, v118, v119
    ds_write_b64 v12, v[52:53] offset:51840
    ds_write_b64 v12, v[54:55] offset:52096
    s_waitcnt lgkmcnt(0)
    s_setprio 0
    s_barrier
    ds_read_b128 v[12:15], v6 offset:51840
    ds_read_b64 v[16:17], v7 offset:2688
    ds_read_b128 v[18:21], v6 offset:49152
    ds_read_b64 v[22:23], v7 offset:0
    v_pk_mul_f32 v[24:25], v[96:97], v[96:97]
    v_pk_mul_f32 v[26:27], v[98:99], v[98:99]
    v_pk_mul_f32 v[28:29], v[100:101], v[100:101]
    v_pk_mul_f32 v[30:31], v[102:103], v[102:103]
    v_pk_fma_f32 v[24:25], v[24:25], s[88:89], v[160:161]
    v_pk_fma_f32 v[26:27], v[26:27], s[88:89], v[160:161]
    v_pk_fma_f32 v[28:29], v[28:29], s[88:89], v[160:161]
    v_pk_fma_f32 v[30:31], v[30:31], s[88:89], v[160:161]
    v_pk_mul_f32 v[24:25], v[24:25], v[96:97]
    v_pk_mul_f32 v[26:27], v[26:27], v[98:99]
    v_pk_mul_f32 v[28:29], v[28:29], v[100:101]
    v_pk_mul_f32 v[30:31], v[30:31], v[102:103]
    v_exp_f32 v24, v24
    v_exp_f32 v25, v25
    v_exp_f32 v26, v26
    v_exp_f32 v27, v27
    v_exp_f32 v28, v28
    v_exp_f32 v29, v29
    v_exp_f32 v30, v30
    v_exp_f32 v31, v31
    v_pk_mul_f32 v[96:97], v[96:97], v[104:105]
    v_pk_mul_f32 v[98:99], v[98:99], v[106:107]
    v_pk_mul_f32 v[100:101], v[100:101], v[108:109]
    v_pk_mul_f32 v[102:103], v[102:103], v[110:111]
    v_pk_add_f32 v[24:25], v[24:25], s[90:91]
    v_pk_add_f32 v[26:27], v[26:27], s[90:91]
    v_pk_add_f32 v[28:29], v[28:29], s[90:91]
    v_pk_add_f32 v[30:31], v[30:31], s[90:91]
    v_rcp_f32 v24, v24
    v_rcp_f32 v25, v25
    v_rcp_f32 v26, v26
    v_rcp_f32 v27, v27
    v_rcp_f32 v28, v28
    v_rcp_f32 v29, v29
    v_rcp_f32 v30, v30
    v_rcp_f32 v31, v31
    s_nop 0
    v_pk_mul_f32 v[96:97], v[96:97], v[24:25]
    v_pk_mul_f32 v[98:99], v[98:99], v[26:27]
    v_pk_mul_f32 v[100:101], v[100:101], v[28:29]
    v_pk_mul_f32 v[102:103], v[102:103], v[30:31]
    v_cvt_pk_bf16_f32 v32, v96, v97
    v_cvt_pk_bf16_f32 v33, v98, v99
    v_cvt_pk_bf16_f32 v34, v100, v101
    v_cvt_pk_bf16_f32 v35, v102, v103
    ds_write_b64 v162, v[32:33]
    ds_write_b64 v162, v[34:35] offset:256
    v_pk_mul_f32 v[24:25], v[144:145], v[144:145]
    v_pk_mul_f32 v[26:27], v[146:147], v[146:147]
    v_pk_mul_f32 v[28:29], v[148:149], v[148:149]
    v_pk_mul_f32 v[30:31], v[150:151], v[150:151]
    v_pk_fma_f32 v[24:25], v[24:25], s[88:89], v[160:161]
    v_pk_fma_f32 v[26:27], v[26:27], s[88:89], v[160:161]
    v_pk_fma_f32 v[28:29], v[28:29], s[88:89], v[160:161]
    v_pk_fma_f32 v[30:31], v[30:31], s[88:89], v[160:161]
    v_pk_mul_f32 v[24:25], v[24:25], v[144:145]
    v_pk_mul_f32 v[26:27], v[26:27], v[146:147]
    v_pk_mul_f32 v[28:29], v[28:29], v[148:149]
    v_pk_mul_f32 v[30:31], v[30:31], v[150:151]
    v_exp_f32 v24, v24
    v_exp_f32 v25, v25
    v_exp_f32 v26, v26
    v_exp_f32 v27, v27
    v_exp_f32 v28, v28
    v_exp_f32 v29, v29
    v_exp_f32 v30, v30
    v_exp_f32 v31, v31
    v_pk_mul_f32 v[144:145], v[144:145], v[152:153]
    v_pk_mul_f32 v[146:147], v[146:147], v[154:155]
    v_pk_mul_f32 v[148:149], v[148:149], v[156:157]
    v_pk_mul_f32 v[150:151], v[150:151], v[158:159]
    v_pk_add_f32 v[24:25], v[24:25], s[90:91]
    v_pk_add_f32 v[26:27], v[26:27], s[90:91]
    v_pk_add_f32 v[28:29], v[28:29], s[90:91]
    v_pk_add_f32 v[30:31], v[30:31], s[90:91]
    v_rcp_f32 v24, v24
    v_rcp_f32 v25, v25
    v_rcp_f32 v26, v26
    v_rcp_f32 v27, v27
    v_rcp_f32 v28, v28
    v_rcp_f32 v29, v29
    v_rcp_f32 v30, v30
    v_rcp_f32 v31, v31
    s_nop 0
    v_pk_mul_f32 v[144:145], v[144:145], v[24:25]
    v_pk_mul_f32 v[146:147], v[146:147], v[26:27]
    v_pk_mul_f32 v[148:149], v[148:149], v[28:29]
    v_pk_mul_f32 v[150:151], v[150:151], v[30:31]
    v_cvt_pk_bf16_f32 v36, v144, v145
    v_cvt_pk_bf16_f32 v37, v146, v147
    v_cvt_pk_bf16_f32 v38, v148, v149
    v_cvt_pk_bf16_f32 v39, v150, v151
    ds_write_b64 v162, v[36:37] offset:4096
    ds_write_b64 v162, v[38:39] offset:4352
    s_branch L_B_join
L_A_short:
    ds_read_b64_tr_b16 v[40:41], v164
    ds_read_b64_tr_b16 v[42:43], v164 offset:256
    ds_read_b128 v[24:27], v160
    ds_read_b64_tr_b16 v[44:45], v162
    ds_read_b64_tr_b16 v[46:47], v162 offset:256
    ds_read_b128 v[28:31], v160 offset:2048
    ds_read_b128 v[32:35], v160 offset:4096
    ds_read_b128 v[36:39], v160 offset:6144
.p2align 6
L_g_S:
    s_waitcnt lgkmcnt(5)
    v_mfma_f32_16x16x32_bf16 v[64:67], v[40:43], v[24:27], v[64:67]
    ds_read_b64_tr_b16 v[48:49], v165
    ds_read_b64_tr_b16 v[50:51], v165 offset:320
    s_waitcnt lgkmcnt(5)
    v_mfma_f32_16x16x32_bf16 v[72:75], v[44:47], v[24:27], v[72:75]
    ds_read_b64_tr_b16 v[52:53], v163
    ds_read_b64_tr_b16 v[54:55], v163 offset:320
    s_waitcnt lgkmcnt(6)
    v_mfma_f32_16x16x32_bf16 v[76:79], v[44:47], v[28:31], v[76:79]
    s_add_u32 s63, s63, 1
    s_cmp_eq_u32 s63, 5
    v_mfma_f32_16x16x32_bf16 v[68:71], v[40:43], v[28:31], v[68:71]
    s_cselect_b32 s87, s89, s88
    s_cselect_b32 s63, 0, s63
    s_waitcnt lgkmcnt(5)
    v_mfma_f32_16x16x32_bf16 v[112:115], v[40:43], v[32:35], v[112:115]
    s_add_u32 s62, s62, 1
    s_cmp_eq_u32 s62, 3
    v_mfma_f32_16x16x32_bf16 v[120:123], v[44:47], v[32:35], v[120:123]
    s_cselect_b32 s86, s91, s90
    s_cselect_b32 s62, 0, s62
    s_waitcnt lgkmcnt(4)
    v_mfma_f32_16x16x32_bf16 v[124:127], v[44:47], v[36:39], v[124:127]
    v_add_u32 v162, s87, v162
    v_add_u32 v163, s87, v163
    v_mfma_f32_16x16x32_bf16 v[116:119], v[40:43], v[36:39], v[116:119]
    v_add_u32 v164, s87, v164
    v_add_u32 v165, s87, v165
    v_add_u32 v160, s86, v160
    s_waitcnt lgkmcnt(0)
    s_barrier
    v_mfma_f32_16x16x32_bf16 v[80:83], v[48:51], v[24:27], v[80:83]
    ds_read_b64_tr_b16 v[40:41], v164
    ds_read_b64_tr_b16 v[42:43], v164 offset:256
    v_mfma_f32_16x16x32_bf16 v[88:91], v[52:55], v[24:27], v[88:91]
    ds_read_b128 v[24:27], v161
    v_mfma_f32_16x16x32_bf16 v[92:95], v[52:55], v[28:31], v[92:95]
    ds_read_b64_tr_b16 v[44:45], v162
    ds_read_b64_tr_b16 v[46:47], v162 offset:256
    v_mfma_f32_16x16x32_bf16 v[84:87], v[48:51], v[28:31], v[84:87]
    ds_read_b128 v[28:31], v161 offset:2048
    v_mfma_f32_16x16x32_bf16 v[128:131], v[48:51], v[32:35], v[128:131]
    v_mfma_f32_16x16x32_bf16 v[136:139], v[52:55], v[32:35], v[136:139]
    ds_read_b128 v[32:35], v161 offset:4096
    v_mfma_f32_16x16x32_bf16 v[140:143], v[52:55], v[36:39], v[140:143]
    v_mfma_f32_16x16x32_bf16 v[132:135], v[48:51], v[36:39], v[132:135]
    ds_read_b128 v[36:39], v161 offset:6144
    s_waitcnt lgkmcnt(5)
    v_mfma_f32_16x16x32_bf16 v[64:67], v[40:43], v[24:27], v[64:67]
    ds_read_b64_tr_b16 v[48:49], v165
    ds_read_b64_tr_b16 v[50:51], v165 offset:320
    s_waitcnt lgkmcnt(5)
    v_mfma_f32_16x16x32_bf16 v[72:75], v[44:47], v[24:27], v[72:75]
    ds_read_b64_tr_b16 v[52:53], v163
    ds_read_b64_tr_b16 v[54:55], v163 offset:320
    s_waitcnt lgkmcnt(6)
    v_mfma_f32_16x16x32_bf16 v[76:79], v[44:47], v[28:31], v[76:79]
    s_add_u32 s63, s63, 1
    s_cmp_eq_u32 s63, 5
    v_mfma_f32_16x16x32_bf16 v[68:71], v[40:43], v[28:31], v[68:71]
    s_cselect_b32 s87, s89, s88
    s_cselect_b32 s63, 0, s63
    s_waitcnt lgkmcnt(5)
    v_mfma_f32_16x16x32_bf16 v[112:115], v[40:43], v[32:35], v[112:115]
    v_add_u32 v162, s87, v162
    v_add_u32 v163, s87, v163
    v_mfma_f32_16x16x32_bf16 v[120:123], v[44:47], v[32:35], v[120:123]
    v_add_u32 v164, s87, v164
    v_add_u32 v165, s87, v165
    s_waitcnt lgkmcnt(4)
    v_mfma_f32_16x16x32_bf16 v[124:127], v[44:47], v[36:39], v[124:127]
    v_add_u32 v161, s86, v161
    v_mfma_f32_16x16x32_bf16 v[116:119], v[40:43], v[36:39], v[116:119]
    s_waitcnt lgkmcnt(0)
    s_barrier
    v_mfma_f32_16x16x32_bf16 v[80:83], v[48:51], v[24:27], v[80:83]
    ds_read_b64_tr_b16 v[40:41], v164
    ds_read_b64_tr_b16 v[42:43], v164 offset:256
    v_mfma_f32_16x16x32_bf16 v[88:91], v[52:55], v[24:27], v[88:91]
    ds_read_b128 v[24:27], v160
    v_mfma_f32_16x16x32_bf16 v[92:95], v[52:55], v[28:31], v[92:95]
    ds_read_b64_tr_b16 v[44:45], v162
    ds_read_b64_tr_b16 v[46:47], v162 offset:256
    v_mfma_f32_16x16x32_bf16 v[84:87], v[48:51], v[28:31], v[84:87]
    ds_read_b128 v[28:31], v160 offset:2048
    v_mfma_f32_16x16x32_bf16 v[128:131], v[48:51], v[32:35], v[128:131]
    s_add_u32 s21, s21, 1
    v_mfma_f32_16x16x32_bf16 v[136:139], v[52:55], v[32:35], v[136:139]
    ds_read_b128 v[32:35], v160 offset:4096
    v_mfma_f32_16x16x32_bf16 v[140:143], v[52:55], v[36:39], v[140:143]
    s_cmp_lt_u32 s21, 10
    v_mfma_f32_16x16x32_bf16 v[132:135], v[48:51], v[36:39], v[132:135]
    ds_read_b128 v[36:39], v160 offset:6144
    s_cbranch_scc1 L_g_S
    s_waitcnt lgkmcnt(0)
    s_nop 15
    s_mov_b32 s26, 0x3ea52b5c
    s_mov_b32 s27, 0x3ea52b5c
    s_mov_b32 s98, -1
    s_mov_b32 s99, 0xffff
    v_cvt_pk_bf16_f32 v24, v72, v73
    v_cvt_pk_bf16_f32 v25, v74, v75
    v_cvt_pk_bf16_f32 v26, v76, v77
    v_cvt_pk_bf16_f32 v27, v78, v79
    v_pk_mul_f32 v[80:81], v[80:81], v[10:11] op_sel_hi:[1,0]
    v_pk_mul_f32 v[82:83], v[82:83], v[10:11] op_sel_hi:[1,0]
    v_pk_mul_f32 v[84:85], v[84:85], v[10:11] op_sel_hi:[1,0]
    v_pk_mul_f32 v[86:87], v[86:87], v[10:11] op_sel_hi:[1,0]
    ds_write_b64 v12, v[24:25]
    ds_write_b64 v12, v[26:27] offset:256
    v_cvt_pk_bf16_f32 v28, v88, v89
    v_cvt_pk_bf16_f32 v29, v90, v91
    v_cvt_pk_bf16_f32 v30, v92, v93
    v_cvt_pk_bf16_f32 v31, v94, v95
    v_cvt_pk_bf16_f32 v32, v80, v81
    v_cvt_pk_bf16_f32 v33, v82, v83
    v_cvt_pk_bf16_f32 v34, v84, v85
    v_cvt_pk_bf16_f32 v35, v86, v87
    v_cndmask_b32 v28, v9, v28, s[98:99]
    v_cndmask_b32 v30, v9, v30, s[98:99]
    ds_write_b16 v14, v28 offset:256
    ds_write_b16_d16_hi v14, v28 offset:272
    ds_write_b16 v14, v30 offset:960
    ds_write_b16_d16_hi v14, v30 offset:976
    v_cvt_pk_bf16_f32 v36, v120, v121
    v_cvt_pk_bf16_f32 v37, v122, v123
    v_cvt_pk_bf16_f32 v38, v124, v125
    v_cvt_pk_bf16_f32 v39, v126, v127
    v_pk_mul_f32 v[128:129], v[128:129], v[10:11] op_sel_hi:[1,0]
    v_pk_mul_f32 v[130:131], v[130:131], v[10:11] op_sel_hi:[1,0]
    v_pk_mul_f32 v[132:133], v[132:133], v[10:11] op_sel_hi:[1,0]
    v_pk_mul_f32 v[134:135], v[134:135], v[10:11] op_sel_hi:[1,0]
    ds_write_b64 v12, v[36:37] offset:2688
    ds_write_b64 v12, v[38:39] offset:2944
    v_cvt_pk_bf16_f32 v40, v136, v137
    v_cvt_pk_bf16_f32 v41, v138, v139
    v_cvt_pk_bf16_f32 v42, v140, v141
    v_cvt_pk_bf16_f32 v43, v142, v143
    v_cvt_pk_bf16_f32 v44, v128, v129
    v_cvt_pk_bf16_f32 v45, v130, v131
    v_cvt_pk_bf16_f32 v46, v132, v133
    v_cvt_pk_bf16_f32 v47, v134, v135
    v_cndmask_b32 v40, v9, v40, s[98:99]
    v_cndmask_b32 v42, v9, v42, s[98:99]
    ds_write_b16 v14, v40 offset:2944
    ds_write_b16_d16_hi v14, v40 offset:2960
    ds_write_b16 v14, v42 offset:3648
    ds_write_b16_d16_hi v14, v42 offset:3664
    s_mov_b32 exec_hi, 0xffff
    ds_write_b16 v14, v29 offset:288
    ds_write_b16_d16_hi v14, v29 offset:304
    ds_write_b16 v14, v31 offset:992
    ds_write_b16_d16_hi v14, v31 offset:1008
    ds_write_b16 v14, v41 offset:2976
    ds_write_b16_d16_hi v14, v41 offset:2992
    ds_write_b16 v14, v43 offset:3680
    ds_write_b16_d16_hi v14, v43 offset:3696
    s_mov_b32 exec_hi, 0
    ds_write_b64 v13, v[32:33]
    ds_write_b64 v13, v[34:35] offset:128
    ds_write_b64 v13, v[44:45] offset:2688
    ds_write_b64 v13, v[46:47] offset:2816
    s_mov_b32 exec_lo, 0
    s_mov_b32 exec_hi, -1
    ds_write_b16 v14, v32
    ds_write_b16_d16_hi v14, v32 offset:16
    ds_write_b16 v14, v33 offset:32
    ds_write_b16_d16_hi v14, v33 offset:48
    ds_write_b16 v14, v34 offset:704
    ds_write_b16_d16_hi v14, v34 offset:720
    ds_write_b16 v14, v35 offset:736
    ds_write_b16_d16_hi v14, v35 offset:752
    ds_write_b16 v14, v44 offset:2688
    ds_write_b16_d16_hi v14, v44 offset:2704
    ds_write_b16 v14, v45 offset:2720
    ds_write_b16_d16_hi v14, v45 offset:2736
    ds_write_b16 v14, v46 offset:3392
    ds_write_b16_d16_hi v14, v46 offset:3408
    ds_write_b16 v14, v47 offset:3424
    ds_write_b16_d16_hi v14, v47 offset:3440
    s_mov_b32 exec_lo, -1
    v_pk_mul_f32 v[64:65], v[64:65], s[26:27]
    v_pk_mul_f32 v[66:67], v[66:67], s[26:27]
    v_pk_mul_f32 v[68:69], v[68:69], s[26:27]
    v_pk_mul_f32 v[70:71], v[70:71], s[26:27]
    v_cvt_pk_bf16_f32 v48, v64, v65
    v_cvt_pk_bf16_f32 v49, v66, v67
    v_cvt_pk_bf16_f32 v50, v68, v69
    v_cvt_pk_bf16_f32 v51, v70, v71
    ds_write_b64 v12, v[48:49] offset:49152
    ds_write_b64 v12, v[50:51] offset:49408
    v_pk_mul_f32 v[112:113], v[112:113], s[26:27]
    v_pk_mul_f32 v[114:115], v[114:115], s[26:27]
    v_pk_mul_f32 v[116:117], v[116:117], s[26:27]
    v_pk_mul_f32 v[118:119], v[118:119], s[26:27]
    v_cvt_pk_bf16_f32 v52, v112, v113
    v_cvt_pk_bf16_f32 v53, v114, v115
    v_cvt_pk_bf16_f32 v54, v116, v117
    v_cvt_pk_bf16_f32 v55, v118, v119
    ds_write_b64 v12, v[52:53] offset:51840
    ds_write_b64 v12, v[54:55] offset:52096
    s_waitcnt lgkmcnt(0)
    s_barrier
    ds_read_b128 v[12:15], v6 offset:51840
    ds_read_b64 v[16:17], v7 offset:2688
    ds_read_b128 v[18:21], v6 offset:49152
    ds_read_b64 v[22:23], v7 offset:0
    s_branch L_B_join
L_B:
    v_add_u32 v7, 50176, v30
    s_cmp_lt_u32 s20, 27
    s_cbranch_scc0 L_B_help
    v_xor_b32 v164, 2, v29
    v_lshl_add_u32 v164, v164, 4, v28
    v_xor_b32 v165, 4, v29
    v_lshl_add_u32 v165, v165, 4, v28
    v_xor_b32 v166, 6, v29
    v_lshl_add_u32 v166, v166, 4, v28
    v_mov_b64 v[64:65], 0
    v_mov_b64 v[66:67], 0
    v_mov_b64 v[68:69], 0
    v_mov_b64 v[70:71], 0
    v_mov_b64 v[72:73], 0
    v_mov_b64 v[74:75], 0
    v_mov_b64 v[76:77], 0
    v_mov_b64 v[78:79], 0
    v_mov_b64 v[80:81], 0
    v_mov_b64 v[82:83], 0
    v_mov_b64 v[84:85], 0
    v_mov_b64 v[86:87], 0
    v_mov_b64 v[88:89], 0
    v_mov_b64 v[90:91], 0
    v_mov_b64 v[92:93], 0
    v_mov_b64 v[94:95], 0
    v_mov_b64 v[96:97], 0
    v_mov_b64 v[98:99], 0
    v_mov_b64 v[100:101], 0
    v_mov_b64 v[102:103], 0
    v_mov_b64 v[104:105], 0
    v_mov_b64 v[106:107], 0
    v_mov_b64 v[108:109], 0
    v_mov_b64 v[110:111], 0
    v_mov_b64 v[112:113], 0
    v_mov_b64 v[114:115], 0
    v_mov_b64 v[116:117], 0
    v_mov_b64 v[118:119], 0
    v_mov_b64 v[120:121], 0
    v_mov_b64 v[122:123], 0
    v_mov_b64 v[124:125], 0
    v_mov_b64 v[126:127], 0
    v_mov_b64 v[128:129], 0
    v_mov_b64 v[130:131], 0
    v_mov_b64 v[132:133], 0
    v_mov_b64 v[134:135], 0
    v_mov_b64 v[136:137], 0
    v_mov_b64 v[138:139], 0
    v_mov_b64 v[140:141], 0
    v_mov_b64 v[142:143], 0
    v_mov_b64 v[144:145], 0
    v_mov_b64 v[146:147], 0
    v_mov_b64 v[148:149], 0
    v_mov_b64 v[150:151], 0
    v_mov_b64 v[152:153], 0
    v_mov_b64 v[154:155], 0
    v_mov_b64 v[156:157], 0
    v_mov_b64 v[158:159], 0
    s_barrier
    ds_read_b64_tr_b16 v[40:41], v164
    ds_read_b64_tr_b16 v[42:43], v164 offset:512
    ds_read_b64_tr_b16 v[44:45], v164 offset:4096
    ds_read_b64_tr_b16 v[46:47], v164 offset:4608
    ds_read_b128 v[24:27], v160
    ds_read_b64_tr_b16 v[48:49], v165
    ds_read_b64_tr_b16 v[50:51], v165 offset:512
    ds_read_b128 v[28:31], v160 offset:2048
    ds_read_b128 v[32:35], v160 offset:4096
    ds_read_b128 v[36:39], v160 offset:6144
.p2align 6
L_g_B:
    s_waitcnt lgkmcnt(5)
    v_mfma_f32_16x16x32_bf16 v[64:67], v[40:43], v[24:27], v[64:67]
    ds_read_b64_tr_b16 v[52:53], v165 offset:4096
    ds_read_b64_tr_b16 v[54:55], v165 offset:4608
    v_mfma_f32_16x16x32_bf16 v[72:75], v[44:47], v[24:27], v[72:75]
    ds_read_b64_tr_b16 v[56:57], v166
    ds_read_b64_tr_b16 v[58:59], v166 offset:512
    s_waitcnt lgkmcnt(7)
    v_mfma_f32_16x16x32_bf16 v[80:83], v[48:51], v[24:27], v[80:83]
    ds_read_b64_tr_b16 v[60:61], v166 offset:4096
    ds_read_b64_tr_b16 v[62:63], v166 offset:4608
    s_waitcnt lgkmcnt(8)
    v_mfma_f32_16x16x32_bf16 v[84:87], v[48:51], v[28:31], v[84:87]
    s_add_u32 s63, s63, 1
    s_cmp_eq_u32 s63, 5
    v_mfma_f32_16x16x32_bf16 v[76:79], v[44:47], v[28:31], v[76:79]
    s_cselect_b32 s87, s89, s88
    s_cselect_b32 s63, 0, s63
    v_mfma_f32_16x16x32_bf16 v[68:71], v[40:43], v[28:31], v[68:71]
    s_add_u32 s62, s62, 1
    s_cmp_eq_u32 s62, 3
    s_waitcnt lgkmcnt(7)
    v_mfma_f32_16x16x32_bf16 v[112:115], v[40:43], v[32:35], v[112:115]
    s_cselect_b32 s86, s91, s90
    s_cselect_b32 s62, 0, s62
    v_mfma_f32_16x16x32_bf16 v[120:123], v[44:47], v[32:35], v[120:123]
    v_add_u32 v164, s87, v164
    v_add_u32 v165, s87, v165
    v_mfma_f32_16x16x32_bf16 v[128:131], v[48:51], v[32:35], v[128:131]
    v_add_u32 v166, s87, v166
    v_add_u32 v160, s86, v160
    s_waitcnt lgkmcnt(6)
    v_mfma_f32_16x16x32_bf16 v[132:135], v[48:51], v[36:39], v[132:135]
    v_mfma_f32_16x16x32_bf16 v[124:127], v[44:47], v[36:39], v[124:127]
    v_mfma_f32_16x16x32_bf16 v[116:119], v[40:43], v[36:39], v[116:119]
    s_waitcnt lgkmcnt(0)
    s_barrier
    v_mfma_f32_16x16x32_bf16 v[88:91], v[52:55], v[24:27], v[88:91]
    ds_read_b64_tr_b16 v[40:41], v164
    ds_read_b64_tr_b16 v[42:43], v164 offset:512
    v_mfma_f32_16x16x32_bf16 v[96:99], v[56:59], v[24:27], v[96:99]
    ds_read_b64_tr_b16 v[44:45], v164 offset:4096
    ds_read_b64_tr_b16 v[46:47], v164 offset:4608
    v_mfma_f32_16x16x32_bf16 v[104:107], v[60:63], v[24:27], v[104:107]
    ds_read_b128 v[24:27], v161
    v_mfma_f32_16x16x32_bf16 v[108:111], v[60:63], v[28:31], v[108:111]
    ds_read_b64_tr_b16 v[48:49], v165
    ds_read_b64_tr_b16 v[50:51], v165 offset:512
    v_mfma_f32_16x16x32_bf16 v[100:103], v[56:59], v[28:31], v[100:103]
    v_mfma_f32_16x16x32_bf16 v[92:95], v[52:55], v[28:31], v[92:95]
    ds_read_b128 v[28:31], v161 offset:2048
    v_mfma_f32_16x16x32_bf16 v[136:139], v[52:55], v[32:35], v[136:139]
    v_mfma_f32_16x16x32_bf16 v[144:147], v[56:59], v[32:35], v[144:147]
    v_mfma_f32_16x16x32_bf16 v[152:155], v[60:63], v[32:35], v[152:155]
    ds_read_b128 v[32:35], v161 offset:4096
    v_mfma_f32_16x16x32_bf16 v[156:159], v[60:63], v[36:39], v[156:159]
    v_mfma_f32_16x16x32_bf16 v[148:151], v[56:59], v[36:39], v[148:151]
    v_mfma_f32_16x16x32_bf16 v[140:143], v[52:55], v[36:39], v[140:143]
    ds_read_b128 v[36:39], v161 offset:6144
    s_waitcnt lgkmcnt(5)
    v_mfma_f32_16x16x32_bf16 v[64:67], v[40:43], v[24:27], v[64:67]
    ds_read_b64_tr_b16 v[52:53], v165 offset:4096
    ds_read_b64_tr_b16 v[54:55], v165 offset:4608
    v_mfma_f32_16x16x32_bf16 v[72:75], v[44:47], v[24:27], v[72:75]
    ds_read_b64_tr_b16 v[56:57], v166
    ds_read_b64_tr_b16 v[58:59], v166 offset:512
    s_waitcnt lgkmcnt(7)
    v_mfma_f32_16x16x32_bf16 v[80:83], v[48:51], v[24:27], v[80:83]
    ds_read_b64_tr_b16 v[60:61], v166 offset:4096
    ds_read_b64_tr_b16 v[62:63], v166 offset:4608
    s_waitcnt lgkmcnt(8)
    v_mfma_f32_16x16x32_bf16 v[84:87], v[48:51], v[28:31], v[84:87]
    s_add_u32 s63, s63, 1
    s_cmp_eq_u32 s63, 5
    v_mfma_f32_16x16x32_bf16 v[76:79], v[44:47], v[28:31], v[76:79]
    s_cselect_b32 s87, s89, s88
    s_cselect_b32 s63, 0, s63
    v_mfma_f32_16x16x32_bf16 v[68:71], v[40:43], v[28:31], v[68:71]
    v_add_u32 v164, s87, v164
    v_add_u32 v165, s87, v165
    s_waitcnt lgkmcnt(7)
    v_mfma_f32_16x16x32_bf16 v[112:115], v[40:43], v[32:35], v[112:115]
    v_add_u32 v166, s87, v166
    v_add_u32 v161, s86, v161
    v_mfma_f32_16x16x32_bf16 v[120:123], v[44:47], v[32:35], v[120:123]
    v_mfma_f32_16x16x32_bf16 v[128:131], v[48:51], v[32:35], v[128:131]
    s_waitcnt lgkmcnt(6)
    v_mfma_f32_16x16x32_bf16 v[132:135], v[48:51], v[36:39], v[132:135]
    v_mfma_f32_16x16x32_bf16 v[124:127], v[44:47], v[36:39], v[124:127]
    v_mfma_f32_16x16x32_bf16 v[116:119], v[40:43], v[36:39], v[116:119]
    s_waitcnt lgkmcnt(0)
    s_barrier
    v_mfma_f32_16x16x32_bf16 v[88:91], v[52:55], v[24:27], v[88:91]
    ds_read_b64_tr_b16 v[40:41], v164
    ds_read_b64_tr_b16 v[42:43], v164 offset:512
    v_mfma_f32_16x16x32_bf16 v[96:99], v[56:59], v[24:27], v[96:99]
    ds_read_b64_tr_b16 v[44:45], v164 offset:4096
    ds_read_b64_tr_b16 v[46:47], v164 offset:4608
    v_mfma_f32_16x16x32_bf16 v[104:107], v[60:63], v[24:27], v[104:107]
    ds_read_b128 v[24:27], v160
    v_mfma_f32_16x16x32_bf16 v[108:111], v[60:63], v[28:31], v[108:111]
    ds_read_b64_tr_b16 v[48:49], v165
    ds_read_b64_tr_b16 v[50:51], v165 offset:512
    v_mfma_f32_16x16x32_bf16 v[100:103], v[56:59], v[28:31], v[100:103]
    s_add_u32 s21, s21, 1
    v_mfma_f32_16x16x32_bf16 v[92:95], v[52:55], v[28:31], v[92:95]
    ds_read_b128 v[28:31], v160 offset:2048
    v_mfma_f32_16x16x32_bf16 v[136:139], v[52:55], v[32:35], v[136:139]
    s_cmp_lt_u32 s21, 10
    v_mfma_f32_16x16x32_bf16 v[144:147], v[56:59], v[32:35], v[144:147]
    v_mfma_f32_16x16x32_bf16 v[152:155], v[60:63], v[32:35], v[152:155]
    ds_read_b128 v[32:35], v160 offset:4096
    v_mfma_f32_16x16x32_bf16 v[156:159], v[60:63], v[36:39], v[156:159]
    v_mfma_f32_16x16x32_bf16 v[148:151], v[56:59], v[36:39], v[148:151]
    v_mfma_f32_16x16x32_bf16 v[140:143], v[52:55], v[36:39], v[140:143]
    ds_read_b128 v[36:39], v160 offset:6144
    s_cbranch_scc1 L_g_B
    s_waitcnt lgkmcnt(0)
    s_mov_b32 s88, 0xbdd2d3e8
    s_mov_b32 s89, 0xbdd2d3e8
    s_mov_b32 s90, 1.0
    s_mov_b32 s91, 1.0
    v_mov_b32 v160, 0xc0135761
    v_mov_b32 v161, 0xc0135761
    s_lshl_b32 s24, s16, 13
    s_add_u32 s24, s24, 98304
    v_add_u32 v162, s24, v8
    s_nop 7
    v_pk_mul_f32 v[24:25], v[64:65], v[64:65]
    v_pk_mul_f32 v[26:27], v[66:67], v[66:67]
    v_pk_mul_f32 v[28:29], v[68:69], v[68:69]
    v_pk_mul_f32 v[30:31], v[70:71], v[70:71]
    v_pk_fma_f32 v[24:25], v[24:25], s[88:89], v[160:161]
    v_pk_fma_f32 v[26:27], v[26:27], s[88:89], v[160:161]
    v_pk_fma_f32 v[28:29], v[28:29], s[88:89], v[160:161]
    v_pk_fma_f32 v[30:31], v[30:31], s[88:89], v[160:161]
    v_pk_mul_f32 v[24:25], v[24:25], v[64:65]
    v_pk_mul_f32 v[26:27], v[26:27], v[66:67]
    v_pk_mul_f32 v[28:29], v[28:29], v[68:69]
    v_pk_mul_f32 v[30:31], v[30:31], v[70:71]
    v_exp_f32 v24, v24
    v_exp_f32 v25, v25
    v_exp_f32 v26, v26
    v_exp_f32 v27, v27
    v_exp_f32 v28, v28
    v_exp_f32 v29, v29
    v_exp_f32 v30, v30
    v_exp_f32 v31, v31
    v_pk_mul_f32 v[64:65], v[64:65], v[72:73]
    v_pk_mul_f32 v[66:67], v[66:67], v[74:75]
    v_pk_mul_f32 v[68:69], v[68:69], v[76:77]
    v_pk_mul_f32 v[70:71], v[70:71], v[78:79]
    v_pk_add_f32 v[24:25], v[24:25], s[90:91]
    v_pk_add_f32 v[26:27], v[26:27], s[90:91]
    v_pk_add_f32 v[28:29], v[28:29], s[90:91]
    v_pk_add_f32 v[30:31], v[30:31], s[90:91]
    v_rcp_f32 v24, v24
    v_rcp_f32 v25, v25
    v_rcp_f32 v26, v26
    v_rcp_f32 v27, v27
    v_rcp_f32 v28, v28
    v_rcp_f32 v29, v29
    v_rcp_f32 v30, v30
    v_rcp_f32 v31, v31
    s_nop 0
    v_pk_mul_f32 v[64:65], v[64:65], v[24:25]
    v_pk_mul_f32 v[66:67], v[66:67], v[26:27]
    v_pk_mul_f32 v[68:69], v[68:69], v[28:29]
    v_pk_mul_f32 v[70:71], v[70:71], v[30:31]
    v_cvt_pk_bf16_f32 v32, v64, v65
    v_cvt_pk_bf16_f32 v33, v66, v67
    v_cvt_pk_bf16_f32 v34, v68, v69
    v_cvt_pk_bf16_f32 v35, v70, v71
    ds_write_b64 v162, v[32:33] offset:1024
    ds_write_b64 v162, v[34:35] offset:1280
    v_pk_mul_f32 v[24:25], v[112:113], v[112:113]
    v_pk_mul_f32 v[26:27], v[114:115], v[114:115]
    v_pk_mul_f32 v[28:29], v[116:117], v[116:117]
    v_pk_mul_f32 v[30:31], v[118:119], v[118:119]
    v_pk_fma_f32 v[24:25], v[24:25], s[88:89], v[160:161]
    v_pk_fma_f32 v[26:27], v[26:27], s[88:89], v[160:161]
    v_pk_fma_f32 v[28:29], v[28:29], s[88:89], v[160:161]
    v_pk_fma_f32 v[30:31], v[30:31], s[88:89], v[160:161]
    v_pk_mul_f32 v[24:25], v[24:25], v[112:113]
    v_pk_mul_f32 v[26:27], v[26:27], v[114:115]
    v_pk_mul_f32 v[28:29], v[28:29], v[116:117]
    v_pk_mul_f32 v[30:31], v[30:31], v[118:119]
    v_exp_f32 v24, v24
    v_exp_f32 v25, v25
    v_exp_f32 v26, v26
    v_exp_f32 v27, v27
    v_exp_f32 v28, v28
    v_exp_f32 v29, v29
    v_exp_f32 v30, v30
    v_exp_f32 v31, v31
    v_pk_mul_f32 v[112:113], v[112:113], v[120:121]
    v_pk_mul_f32 v[114:115], v[114:115], v[122:123]
    v_pk_mul_f32 v[116:117], v[116:117], v[124:125]
    v_pk_mul_f32 v[118:119], v[118:119], v[126:127]
    v_pk_add_f32 v[24:25], v[24:25], s[90:91]
    v_pk_add_f32 v[26:27], v[26:27], s[90:91]
    v_pk_add_f32 v[28:29], v[28:29], s[90:91]
    v_pk_add_f32 v[30:31], v[30:31], s[90:91]
    v_rcp_f32 v24, v24
    v_rcp_f32 v25, v25
    v_rcp_f32 v26, v26
    v_rcp_f32 v27, v27
    v_rcp_f32 v28, v28
    v_rcp_f32 v29, v29
    v_rcp_f32 v30, v30
    v_rcp_f32 v31, v31
    s_nop 0
    v_pk_mul_f32 v[112:113], v[112:113], v[24:25]
    v_pk_mul_f32 v[114:115], v[114:115], v[26:27]
    v_pk_mul_f32 v[116:117], v[116:117], v[28:29]
    v_pk_mul_f32 v[118:119], v[118:119], v[30:31]
    v_cvt_pk_bf16_f32 v36, v112, v113
    v_cvt_pk_bf16_f32 v37, v114, v115
    v_cvt_pk_bf16_f32 v38, v116, v117
    v_cvt_pk_bf16_f32 v39, v118, v119
    ds_write_b64 v162, v[36:37] offset:5120
    ds_write_b64 v162, v[38:39] offset:5376
    s_barrier
    ds_read_b128 v[12:15], v6 offset:49152
    ds_read_b64 v[16:17], v7 offset:0
    ds_read_b128 v[18:21], v6 offset:51840
    ds_read_b64 v[22:23], v7 offset:2688
    v_pk_mul_f32 v[24:25], v[80:81], v[80:81]
    v_pk_mul_f32 v[26:27], v[82:83], v[82:83]
    v_pk_mul_f32 v[28:29], v[84:85], v[84:85]
    v_pk_mul_f32 v[30:31], v[86:87], v[86:87]
    v_pk_fma_f32 v[24:25], v[24:25], s[88:89], v[160:161]
    v_pk_fma_f32 v[26:27], v[26:27], s[88:89], v[160:161]
    v_pk_fma_f32 v[28:29], v[28:29], s[88:89], v[160:161]
    v_pk_fma_f32 v[30:31], v[30:31], s[88:89], v[160:161]
    v_pk_mul_f32 v[24:25], v[24:25], v[80:81]
    v_pk_mul_f32 v[26:27], v[26:27], v[82:83]
    v_pk_mul_f32 v[28:29], v[28:29], v[84:85]
    v_pk_mul_f32 v[30:31], v[30:31], v[86:87]
    v_exp_f32 v24, v24
    v_exp_f32 v25, v25
    v_exp_f32 v26, v26
    v_exp_f32 v27, v27
    v_exp_f32 v28, v28
    v_exp_f32 v29, v29
    v_exp_f32 v30, v30
    v_exp_f32 v31, v31
    v_pk_mul_f32 v[80:81], v[80:81], v[88:89]
    v_pk_mul_f32 v[82:83], v[82:83], v[90:91]
    v_pk_mul_f32 v[84:85], v[84:85], v[92:93]
    v_pk_mul_f32 v[86:87], v[86:87], v[94:95]
    v_pk_add_f32 v[24:25], v[24:25], s[90:91]
    v_pk_add_f32 v[26:27], v[26:27], s[90:91]
    v_pk_add_f32 v[28:29], v[28:29], s[90:91]
    v_pk_add_f32 v[30:31], v[30:31], s[90:91]
    v_rcp_f32 v24, v24
    v_rcp_f32 v25, v25
    v_rcp_f32 v26, v26
    v_rcp_f32 v27, v27
    v_rcp_f32 v28, v28
    v_rcp_f32 v29, v29
    v_rcp_f32 v30, v30
    v_rcp_f32 v31, v31
    s_nop 0
    v_pk_mul_f32 v[80:81], v[80:81], v[24:25]
    v_pk_mul_f32 v[82:83], v[82:83], v[26:27]
    v_pk_mul_f32 v[84:85], v[84:85], v[28:29]
    v_pk_mul_f32 v[86:87], v[86:87], v[30:31]
    v_cvt_pk_bf16_f32 v40, v80, v81
    v_cvt_pk_bf16_f32 v41, v82, v83
    v_cvt_pk_bf16_f32 v42, v84, v85
    v_cvt_pk_bf16_f32 v43, v86, v87
    ds_write_b64 v162, v[40:41] offset:2048
    ds_write_b64 v162, v[42:43] offset:2304
    v_pk_mul_f32 v[24:25], v[128:129], v[128:129]
    v_pk_mul_f32 v[26:27], v[130:131], v[130:131]
    v_pk_mul_f32 v[28:29], v[132:133], v[132:133]
    v_pk_mul_f32 v[30:31], v[134:135], v[134:135]
    v_pk_fma_f32 v[24:25], v[24:25], s[88:89], v[160:161]
    v_pk_fma_f32 v[26:27], v[26:27], s[88:89], v[160:161]
    v_pk_fma_f32 v[28:29], v[28:29], s[88:89], v[160:161]
    v_pk_fma_f32 v[30:31], v[30:31], s[88:89], v[160:161]
    v_pk_mul_f32 v[24:25], v[24:25], v[128:129]
    v_pk_mul_f32 v[26:27], v[26:27], v[130:131]
    v_pk_mul_f32 v[28:29], v[28:29], v[132:133]
    v_pk_mul_f32 v[30:31], v[30:31], v[134:135]
    v_exp_f32 v24, v24
    v_exp_f32 v25, v25
    v_exp_f32 v26, v26
    v_exp_f32 v27, v27
    v_exp_f32 v28, v28
    v_exp_f32 v29, v29
    v_exp_f32 v30, v30
    v_exp_f32 v31, v31
    v_pk_mul_f32 v[128:129], v[128:129], v[136:137]
    v_pk_mul_f32 v[130:131], v[130:131], v[138:139]
    v_pk_mul_f32 v[132:133], v[132:133], v[140:141]
    v_pk_mul_f32 v[134:135], v[134:135], v[142:143]
    v_pk_add_f32 v[24:25], v[24:25], s[90:91]
    v_pk_add_f32 v[26:27], v[26:27], s[90:91]
    v_pk_add_f32 v[28:29], v[28:29], s[90:91]
    v_pk_add_f32 v[30:31], v[30:31], s[90:91]
    v_rcp_f32 v24, v24
    v_rcp_f32 v25, v25
    v_rcp_f32 v26, v26
    v_rcp_f32 v27, v27
    v_rcp_f32 v28, v28
    v_rcp_f32 v29, v29
    v_rcp_f32 v30, v30
    v_rcp_f32 v31, v31
    s_nop 0
    v_pk_mul_f32 v[128:129], v[128:129], v[24:25]
    v_pk_mul_f32 v[130:131], v[130:131], v[26:27]
    v_pk_mul_f32 v[132:133], v[132:133], v[28:29]
    v_pk_mul_f32 v[134:135], v[134:135], v[30:31]
    v_cvt_pk_bf16_f32 v44, v128, v129
    v_cvt_pk_bf16_f32 v45, v130, v131
    v_cvt_pk_bf16_f32 v46, v132, v133
    v_cvt_pk_bf16_f32 v47, v134, v135
    ds_write_b64 v162, v[44:45] offset:6144
    ds_write_b64 v162, v[46:47] offset:6400
    v_pk_mul_f32 v[24:25], v[96:97], v[96:97]
    v_pk_mul_f32 v[26:27], v[98:99], v[98:99]
    v_pk_mul_f32 v[28:29], v[100:101], v[100:101]
    v_pk_mul_f32 v[30:31], v[102:103], v[102:103]
    v_pk_fma_f32 v[24:25], v[24:25], s[88:89], v[160:161]
    v_pk_fma_f32 v[26:27], v[26:27], s[88:89], v[160:161]
    v_pk_fma_f32 v[28:29], v[28:29], s[88:89], v[160:161]
    v_pk_fma_f32 v[30:31], v[30:31], s[88:89], v[160:161]
    v_pk_mul_f32 v[24:25], v[24:25], v[96:97]
    v_pk_mul_f32 v[26:27], v[26:27], v[98:99]
    v_pk_mul_f32 v[28:29], v[28:29], v[100:101]
    v_pk_mul_f32 v[30:31], v[30:31], v[102:103]
    v_exp_f32 v24, v24
    v_exp_f32 v25, v25
    v_exp_f32 v26, v26
    v_exp_f32 v27, v27
    v_exp_f32 v28, v28
    v_exp_f32 v29, v29
    v_exp_f32 v30, v30
    v_exp_f32 v31, v31
    v_pk_mul_f32 v[96:97], v[96:97], v[104:105]
    v_pk_mul_f32 v[98:99], v[98:99], v[106:107]
    v_pk_mul_f32 v[100:101], v[100:101], v[108:109]
    v_pk_mul_f32 v[102:103], v[102:103], v[110:111]
    v_pk_add_f32 v[24:25], v[24:25], s[90:91]
    v_pk_add_f32 v[26:27], v[26:27], s[90:91]
    v_pk_add_f32 v[28:29], v[28:29], s[90:91]
    v_pk_add_f32 v[30:31], v[30:31], s[90:91]
    v_rcp_f32 v24, v24
    v_rcp_f32 v25, v25
    v_rcp_f32 v26, v26
    v_rcp_f32 v27, v27
    v_rcp_f32 v28, v28
    v_rcp_f32 v29, v29
    v_rcp_f32 v30, v30
    v_rcp_f32 v31, v31
    s_nop 0
    v_pk_mul_f32 v[96:97], v[96:97], v[24:25]
    v_pk_mul_f32 v[98:99], v[98:99], v[26:27]
    v_pk_mul_f32 v[100:101], v[100:101], v[28:29]
    v_pk_mul_f32 v[102:103], v[102:103], v[30:31]
    v_cvt_pk_bf16_f32 v48, v96, v97
    v_cvt_pk_bf16_f32 v49, v98, v99
    v_cvt_pk_bf16_f32 v50, v100, v101
    v_cvt_pk_bf16_f32 v51, v102, v103
    ds_write_b64 v162, v[48:49] offset:3072
    ds_write_b64 v162, v[50:51] offset:3328
    v_pk_mul_f32 v[24:25], v[144:145], v[144:145]
    v_pk_mul_f32 v[26:27], v[146:147], v[146:147]
    v_pk_mul_f32 v[28:29], v[148:149], v[148:149]
    v_pk_mul_f32 v[30:31], v[150:151], v[150:151]
    v_pk_fma_f32 v[24:25], v[24:25], s[88:89], v[160:161]
    v_pk_fma_f32 v[26:27], v[26:27], s[88:89], v[160:161]
    v_pk_fma_f32 v[28:29], v[28:29], s[88:89], v[160:161]
    v_pk_fma_f32 v[30:31], v[30:31], s[88:89], v[160:161]
    v_pk_mul_f32 v[24:25], v[24:25], v[144:145]
    v_pk_mul_f32 v[26:27], v[26:27], v[146:147]
    v_pk_mul_f32 v[28:29], v[28:29], v[148:149]
    v_pk_mul_f32 v[30:31], v[30:31], v[150:151]
    v_exp_f32 v24, v24
    v_exp_f32 v25, v25
    v_exp_f32 v26, v26
    v_exp_f32 v27, v27
    v_exp_f32 v28, v28
    v_exp_f32 v29, v29
    v_exp_f32 v30, v30
    v_exp_f32 v31, v31
    v_pk_mul_f32 v[144:145], v[144:145], v[152:153]
    v_pk_mul_f32 v[146:147], v[146:147], v[154:155]
    v_pk_mul_f32 v[148:149], v[148:149], v[156:157]
    v_pk_mul_f32 v[150:151], v[150:151], v[158:159]
    v_pk_add_f32 v[24:25], v[24:25], s[90:91]
    v_pk_add_f32 v[26:27], v[26:27], s[90:91]
    v_pk_add_f32 v[28:29], v[28:29], s[90:91]
    v_pk_add_f32 v[30:31], v[30:31], s[90:91]
    v_rcp_f32 v24, v24
    v_rcp_f32 v25, v25
    v_rcp_f32 v26, v26
    v_rcp_f32 v27, v27
    v_rcp_f32 v28, v28
    v_rcp_f32 v29, v29
    v_rcp_f32 v30, v30
    v_rcp_f32 v31, v31
    s_nop 0
    v_pk_mul_f32 v[144:145], v[144:145], v[24:25]
    v_pk_mul_f32 v[146:147], v[146:147], v[26:27]
    v_pk_mul_f32 v[148:149], v[148:149], v[28:29]
    v_pk_mul_f32 v[150:151], v[150:151], v[30:31]
    v_cvt_pk_bf16_f32 v52, v144, v145
    v_cvt_pk_bf16_f32 v53, v146, v147
    v_cvt_pk_bf16_f32 v54, v148, v149
    v_cvt_pk_bf16_f32 v55, v150, v151
    ds_write_b64 v162, v[52:53] offset:7168
    ds_write_b64 v162, v[54:55] offset:7424
L_B_join:
    s_waitcnt lgkmcnt(0)
    v_cndmask_b32 v16, 0, v16, s[60:61]
    v_cndmask_b32 v17, 0, v17, s[60:61]
    v_cndmask_b32 v22, 0, v22, s[60:61]
    v_cndmask_b32 v23, 0, v23, s[60:61]
L_att:
    v_mov_b64 v[44:45], 0
    v_mov_b64 v[46:47], 0
    v_mov_b64 v[48:49], 0
    v_mov_b64 v[50:51], 0
    s_mul_i32 s24, s15, 10752
    ds_read_b128 v[24:27], v2
    ds_read_b64 v[28:29], v3
    v_add_u32 v2, s24, v2
    v_add_u32 v3, s24, v3
    v_mfma_f32_32x32x16_bf16 v[52:67], v[44:47], v[44:47], 0
    v_mfma_f32_32x32x16_bf16 v[68:83], v[44:47], v[44:47], 0
    v_mfma_f32_32x32x16_bf16 v[132:147], v[44:47], v[44:47], 0
    s_mov_b32 s21, 0
    s_mov_b32 s23, 0
    s_mov_b32 s30, 24576
    s_mov_b32 s31, 0xffff4000
    s_add_u32 s28, s28, s15
    s_lshl_b32 s18, s28, 7
    s_add_u32 s18, s18, 0x1800000
    v_and_b32 v149, 31, v0
    v_lshlrev_b32 v149, 2, v149
    s_mul_i32 s42, s16, 10
    s_cmp_eq_u32 s15, 0
    s_cselect_b32 s41, s12, 4
    s_cselect_b32 s42, 32, s42
    s_mul_i32 s39, s37, 148
    s_add_u32 s39, s39, s42
    s_mul_i32 s39, s39, 5
    s_add_u32 s39, s39, s41
    s_lshl_b32 s39, s39, 10
    s_add_u32 s39, s39, 0x1487000
    s_waitcnt lgkmcnt(0)
    v_mfma_f32_32x32x8bf16_1k v[84:99], v[28:29], v[16:17], 0
    v_mfma_f32_32x32x8bf16_1k v[100:115], v[28:29], v[22:23], 0
    v_mfma_f32_32x32x16_bf16 v[84:99], v[24:27], v[12:15], v[84:99]
    v_mfma_f32_32x32x16_bf16 v[100:115], v[24:27], v[18:21], v[100:115]
    s_nop 7
    ds_read_b128 v[24:27], v2
    ds_read_b64 v[28:29], v3
    ds_read_b128 v[30:33], v2 offset:2688
    ds_read_b64 v[34:35], v3 offset:2688
    s_nop 3
    v_max3_f32 v6, v84, v85, v86
    v_max3_f32 v6, v6, v87, v88
    v_max3_f32 v6, v6, v89, v90
    v_max3_f32 v6, v6, v91, v92
    v_max3_f32 v6, v6, v93, v94
    v_max3_f32 v6, v6, v95, v96
    v_max3_f32 v6, v6, v97, v98
    v_max_f32 v6, v6, v99
    v_mov_b32 v7, v6
    s_nop 1
    v_permlane32_swap_b32 v6, v7
    s_nop 1
    v_max_f32 v6, v6, v7
    v_sub_f32 v6, 0, v6
    v_and_b32 v7, 0xffff0000, v6
    v_sub_f32 v6, v6, v7
    v_and_b32 v8, 0xffff0000, v6
    v_sub_f32 v6, v6, v8
    v_lshrrev_b32 v7, 16, v7
    v_or_b32 v7, v7, v8
    v_lshrrev_b32 v6, 16, v6
    v_cndmask_b32 v16, v7, v16, s[60:61]
    v_cndmask_b32 v17, v6, v17, s[60:61]
    s_waitcnt lgkmcnt(0)
    v_max3_f32 v6, v100, v101, v102
    v_max3_f32 v6, v6, v103, v104
    v_max3_f32 v6, v6, v105, v106
    v_max3_f32 v6, v6, v107, v108
    v_max3_f32 v6, v6, v109, v110
    v_max3_f32 v6, v6, v111, v112
    v_max3_f32 v6, v6, v113, v114
    v_max_f32 v6, v6, v115
    v_mfma_f32_32x32x8bf16_1k v[84:99], v[28:29], v[16:17], 0
    v_mfma_f32_32x32x16_bf16 v[84:99], v[24:27], v[12:15], v[84:99]
    v_mov_b32 v7, v6
    s_nop 1
    v_permlane32_swap_b32 v6, v7
    s_nop 1
    v_max_f32 v6, v6, v7
    v_sub_f32 v6, 0, v6
    v_and_b32 v7, 0xffff0000, v6
    v_sub_f32 v6, v6, v7
    v_and_b32 v8, 0xffff0000, v6
    v_sub_f32 v6, v6, v8
    v_lshrrev_b32 v7, 16, v7
    v_or_b32 v7, v7, v8
    v_lshrrev_b32 v6, 16, v6
    v_cndmask_b32 v22, v7, v22, s[60:61]
    v_cndmask_b32 v23, v6, v23, s[60:61]
    s_nop 3
.p2align 6
L_loop:
    v_mfma_f32_32x32x8bf16_1k v[100:115], v[28:29], v[22:23], 0
    v_exp_f32 v84, v84
    v_exp_f32 v85, v85
    v_exp_f32 v86, v86
    v_exp_f32 v87, v87
    ds_read_b128 v[36:39], v4
    v_mfma_f32_32x32x16_bf16 v[100:115], v[24:27], v[18:21], v[100:115]
    v_exp_f32 v88, v88
    v_exp_f32 v89, v89
    v_exp_f32 v90, v90
    v_exp_f32 v91, v91
    ds_read_b128 v[40:43], v4 offset:704
    v_smfmac_f32_32x32x32_bf16 v[68:83], v[44:47], v[132:139], v5
    v_exp_f32 v92, v92
    v_exp_f32 v93, v93
    v_exp_f32 v94, v94
    v_exp_f32 v95, v95
    s_cmp_eq_u32 s21, 7
    s_cbranch_scc1 L_wl
L_wl_ret:
    v_smfmac_f32_32x32x32_bf16 v[68:83], v[48:51], v[140:147], v5
    v_exp_f32 v96, v96
    v_exp_f32 v97, v97
    v_exp_f32 v98, v98
    v_exp_f32 v99, v99
    s_waitcnt lgkmcnt(0)
    v_mfma_f32_32x32x8bf16_1k v[116:131], v[34:35], v[16:17], 0
    v_exp_f32 v100, v100
    v_exp_f32 v101, v101
    v_exp_f32 v102, v102
    v_exp_f32 v103, v103
    ds_read_b128 v[24:27], v2 offset:5376
    v_mfma_f32_32x32x16_bf16 v[116:131], v[30:33], v[12:15], v[116:131]
    v_exp_f32 v104, v104
    v_exp_f32 v105, v105
    v_exp_f32 v106, v106
    v_exp_f32 v107, v107
    ds_read_b64 v[28:29], v3 offset:5376
    v_smfmac_f32_32x32x32_bf16 v[52:67], v[36:39], v[84:91], v5
    v_exp_f32 v108, v108
    v_exp_f32 v109, v109
    v_exp_f32 v110, v110
    v_exp_f32 v111, v111
    v_smfmac_f32_32x32x32_bf16 v[52:67], v[40:43], v[92:99], v5
    v_exp_f32 v112, v112
    v_exp_f32 v113, v113
    v_exp_f32 v114, v114
    v_exp_f32 v115, v115
    v_mfma_f32_32x32x8bf16_1k v[132:147], v[34:35], v[22:23], 0
    v_exp_f32 v116, v116
    v_exp_f32 v117, v117
    v_exp_f32 v118, v118
    v_exp_f32 v119, v119
    ds_read_b128 v[44:47], v4 offset:2688
    v_mfma_f32_32x32x16_bf16 v[132:147], v[30:33], v[18:21], v[132:147]
    v_exp_f32 v120, v120
    v_exp_f32 v121, v121
    v_exp_f32 v122, v122
    v_exp_f32 v123, v123
    ds_read_b128 v[48:51], v4 offset:3392
    v_smfmac_f32_32x32x32_bf16 v[68:83], v[36:39], v[100:107], v5
    v_exp_f32 v124, v124
    v_exp_f32 v125, v125
    v_exp_f32 v126, v126
    v_exp_f32 v127, v127
    v_smfmac_f32_32x32x32_bf16 v[68:83], v[40:43], v[108:115], v5
    v_exp_f32 v128, v128
    v_exp_f32 v129, v129
    v_exp_f32 v130, v130
    v_exp_f32 v131, v131
    s_waitcnt lgkmcnt(0)
    v_mfma_f32_32x32x8bf16_1k v[84:99], v[28:29], v[16:17], 0
    v_exp_f32 v132, v132
    v_exp_f32 v133, v133
    v_exp_f32 v134, v134
    v_exp_f32 v135, v135
    ds_read_b128 v[30:33], v2 offset:8064
    v_mfma_f32_32x32x16_bf16 v[84:99], v[24:27], v[12:15], v[84:99]
    v_exp_f32 v136, v136
    v_exp_f32 v137, v137
    v_exp_f32 v138, v138
    v_exp_f32 v139, v139
    ds_read_b64 v[34:35], v3 offset:8064
    v_smfmac_f32_32x32x32_bf16 v[52:67], v[44:47], v[116:123], v5
    v_exp_f32 v140, v140
    v_exp_f32 v141, v141
    v_exp_f32 v142, v142
    v_exp_f32 v143, v143
    s_add_u32 s23, s23, 1
    s_cmp_eq_u32 s23, 3
    s_cselect_b32 s22, s31, s30
    s_cselect_b32 s23, 0, s23
    v_smfmac_f32_32x32x32_bf16 v[52:67], v[48:51], v[124:131], v5
    v_exp_f32 v144, v144
    v_exp_f32 v145, v145
    v_exp_f32 v146, v146
    v_exp_f32 v147, v147
    v_add_u32 v2, s22, v2
    v_add_u32 v3, s22, v3
    v_mfma_f32_32x32x8bf16_1k v[100:115], v[28:29], v[22:23], 0
    v_exp_f32 v84, v84
    v_exp_f32 v85, v85
    v_exp_f32 v86, v86
    v_exp_f32 v87, v87
    ds_read_b128 v[36:39], v4 offset:5376
    v_mfma_f32_32x32x16_bf16 v[100:115], v[24:27], v[18:21], v[100:115]
    v_exp_f32 v88, v88
    v_exp_f32 v89, v89
    v_exp_f32 v90, v90
    v_exp_f32 v91, v91
    ds_read_b128 v[40:43], v4 offset:6080
    v_smfmac_f32_32x32x32_bf16 v[68:83], v[44:47], v[132:139], v5
    v_exp_f32 v92, v92
    v_exp_f32 v93, v93
    v_exp_f32 v94, v94
    v_exp_f32 v95, v95
    v_smfmac_f32_32x32x32_bf16 v[68:83], v[48:51], v[140:147], v5
    v_exp_f32 v96, v96
    v_exp_f32 v97, v97
    v_exp_f32 v98, v98
    v_exp_f32 v99, v99
    s_waitcnt lgkmcnt(0)
    s_barrier
    v_mfma_f32_32x32x8bf16_1k v[116:131], v[34:35], v[16:17], 0
    v_exp_f32 v100, v100
    v_exp_f32 v101, v101
    v_exp_f32 v102, v102
    v_exp_f32 v103, v103
    ds_read_b128 v[24:27], v2
    v_mfma_f32_32x32x16_bf16 v[116:131], v[30:33], v[12:15], v[116:131]
    v_exp_f32 v104, v104
    v_exp_f32 v105, v105
    v_exp_f32 v106, v106
    v_exp_f32 v107, v107
    ds_read_b64 v[28:29], v3
    v_smfmac_f32_32x32x32_bf16 v[52:67], v[36:39], v[84:91], v5
    v_exp_f32 v108, v108
    v_exp_f32 v109, v109
    v_exp_f32 v110, v110
    v_exp_f32 v111, v111
    v_smfmac_f32_32x32x32_bf16 v[52:67], v[40:43], v[92:99], v5
    v_exp_f32 v112, v112
    v_exp_f32 v113, v113
    v_exp_f32 v114, v114
    v_exp_f32 v115, v115
    v_mfma_f32_32x32x8bf16_1k v[132:147], v[34:35], v[22:23], 0
    v_exp_f32 v116, v116
    v_exp_f32 v117, v117
    v_exp_f32 v118, v118
    v_exp_f32 v119, v119
    ds_read_b128 v[44:47], v4 offset:8064
    v_mfma_f32_32x32x16_bf16 v[132:147], v[30:33], v[18:21], v[132:147]
    v_exp_f32 v120, v120
    v_exp_f32 v121, v121
    v_exp_f32 v122, v122
    v_exp_f32 v123, v123
    ds_read_b128 v[48:51], v4 offset:8768
    v_smfmac_f32_32x32x32_bf16 v[68:83], v[36:39], v[100:107], v5
    v_exp_f32 v124, v124
    v_exp_f32 v125, v125
    v_exp_f32 v126, v126
    v_exp_f32 v127, v127
    v_add_u32 v4, s22, v4
    v_smfmac_f32_32x32x32_bf16 v[68:83], v[40:43], v[108:115], v5
    v_exp_f32 v128, v128
    v_exp_f32 v129, v129
    v_exp_f32 v130, v130
    v_exp_f32 v131, v131
    s_waitcnt lgkmcnt(0)
    v_mfma_f32_32x32x8bf16_1k v[84:99], v[28:29], v[16:17], 0
    v_exp_f32 v132, v132
    v_exp_f32 v133, v133
    v_exp_f32 v134, v134
    v_exp_f32 v135, v135
    ds_read_b128 v[30:33], v2 offset:2688
    v_mfma_f32_32x32x16_bf16 v[84:99], v[24:27], v[12:15], v[84:99]
    v_exp_f32 v136, v136
    v_exp_f32 v137, v137
    v_exp_f32 v138, v138
    v_exp_f32 v139, v139
    ds_read_b64 v[34:35], v3 offset:2688
    v_smfmac_f32_32x32x32_bf16 v[52:67], v[44:47], v[116:123], v5
    v_exp_f32 v140, v140
    v_exp_f32 v141, v141
    v_exp_f32 v142, v142
    v_exp_f32 v143, v143
    s_add_u32 s21, s21, 1
    s_cmp_lt_u32 s21, 8
    v_smfmac_f32_32x32x32_bf16 v[52:67], v[48:51], v[124:131], v5
    v_exp_f32 v144, v144
    v_exp_f32 v145, v145
    v_exp_f32 v146, v146
    v_exp_f32 v147, v147
    s_cbranch_scc1 L_loop
    v_smfmac_f32_32x32x32_bf16 v[68:83], v[44:47], v[132:139], v5
    s_mul_i32 s24, s12, 3072
    v_add_u32 v7, s24, v1
    s_xor_b32 s24, s12, 4
    s_mul_i32 s24, s24, 3072
    v_add_u32 v8, s24, v1
    s_nop 0
    ds_write_b128 v7, v[52:55]
    ds_write_b128 v7, v[56:59] offset:1024
    ds_write_b128 v7, v[60:63] offset:2048
    v_smfmac_f32_32x32x32_bf16 v[68:83], v[48:51], v[140:147], v5
    s_waitcnt lgkmcnt(0)
    s_barrier
    ds_read_b128 v[32:35], v8 offset:2048
    ds_read_b128 v[24:27], v8
    ds_read_b128 v[28:31], v8 offset:1024
    s_mul_i32 s24, s28, 148
    s_lshl_b32 s24, s24, 10
    s_add_u32 s24, s24, 0xa1b000
    s_lshl_b32 s25, s13, 10
    s_add_u32 s25, s25, s24
    s_lshl_b32 s26, s13, 8
    s_add_u32 s24, s24, s26
    s_add_u32 s24, s24, 32768
    v_lshlrev_b32 v42, 3, v0
    s_waitcnt lgkmcnt(2)
    v_pk_add_f32 v[60:61], v[76:77], v[32:33]
    v_pk_add_f32 v[62:63], v[78:79], v[34:35]
    v_mov_b32 v6, v60
    v_mov_b32 v7, v60
    s_nop 1
    v_permlane32_swap_b32 v6, v7
    s_nop 1
    v_rcp_f32 v6, v7
    s_waitcnt vmcnt(0) lgkmcnt(1)
    v_pk_add_f32 v[52:53], v[68:69], v[24:25]
    v_pk_add_f32 v[54:55], v[70:71], v[26:27]
    v_mul_f32 v6, v6, v148
    v_pk_mul_f32 v[60:61], v[60:61], v[6:7] op_sel_hi:[1,0]
    v_pk_mul_f32 v[62:63], v[62:63], v[6:7] op_sel_hi:[1,0]
    v_pk_mul_f32 v[8:9], v[60:61], 0
    v_cvt_pk_bf16_f32 v40, v60, v61
    v_pk_fma_f32 v[8:9], v[62:63], 0, v[8:9]
    v_cvt_pk_bf16_f32 v41, v62, v63
    v_pk_mul_f32 v[52:53], v[52:53], v[6:7] op_sel_hi:[1,0]
    v_pk_mul_f32 v[54:55], v[54:55], v[6:7] op_sel_hi:[1,0]
    v_pk_fma_f32 v[8:9], v[52:53], 0, v[8:9]
    v_cvt_pk_bf16_f32 v36, v52, v53
    v_pk_fma_f32 v[8:9], v[54:55], 0, v[8:9]
    v_cvt_pk_bf16_f32 v37, v54, v55
    s_waitcnt lgkmcnt(0)
    v_pk_add_f32 v[56:57], v[72:73], v[28:29]
    v_pk_add_f32 v[58:59], v[74:75], v[30:31]
    v_pk_mul_f32 v[56:57], v[56:57], v[6:7] op_sel_hi:[1,0]
    v_pk_mul_f32 v[58:59], v[58:59], v[6:7] op_sel_hi:[1,0]
    v_pk_fma_f32 v[8:9], v[56:57], 0, v[8:9]
    v_cvt_pk_bf16_f32 v38, v56, v57
    v_pk_fma_f32 v[8:9], v[58:59], 0, v[8:9]
    v_cvt_pk_bf16_f32 v39, v58, v59
L_c1:
    v_add_f32 v8, v8, v9
    v_add_f32 v8, v8, v7
    v_subrev_u32 v8, 0x1f800000, v8
    v_cmp_le_u32 vcc, 0x34000000, v8
    s_nop 0
    s_cbranch_vccnz L_slow
L_st:
    buffer_store_dwordx4 v[36:39], v1, s[8:11], s25 offen sc1
    s_mov_b32 exec_hi, 0
    buffer_store_dwordx2 v[40:41], v42, s[8:11], s24 offen sc1
    s_mov_b32 exec_hi, -1
    s_mul_i32 s44, s36, 151552
    s_add_u32 s44, s44, 0xa1b000
    s_lshl_b32 s24, s12, 12
    s_add_u32 s38, s44, s24
    s_lshl_b32 s25, s12, 10
    s_add_u32 s44, s44, s25
    s_add_u32 s44, s44, 32768
    v_and_b32 v8, 31, v0
    v_lshlrev_b32 v8, 3, v8
    v_lshrrev_b32 v9, 5, v0
    v_lshl_add_u32 v8, v9, 9, v8
    s_barrier
    buffer_load_dwordx4 v[64:67], v1, s[8:11], s38 offen sc1
    buffer_load_dwordx4 v[68:71], v1, s[8:11], s38 offen offset:1024 sc1
    buffer_load_dwordx4 v[72:75], v1, s[8:11], s38 offen offset:2048 sc1
    buffer_load_dwordx4 v[76:79], v1, s[8:11], s38 offen offset:3072 sc1
    buffer_load_dwordx2 v[80:81], v8, s[8:11], s44 offen sc1
    buffer_load_dwordx2 v[82:83], v8, s[8:11], s44 offen offset:256 sc1
    s_lshl_b32 s24, s16, 12
    s_add_u32 s24, s24, 57344
    s_mul_i32 s25, s16, 5120
    s_add_u32 s25, s25, 143360
    s_cmp_eq_u32 s15, 0
    s_cselect_b32 s24, s24, s25
    v_add_u32 v10, s24, v1
    s_lshl_b32 s24, s16, 10
    s_add_u32 s24, s24, 49152
    v_add_u32 v11, s24, v1
    ds_read_b128 v[116:119], v10
    ds_read_b128 v[120:123], v10 offset:1024
    ds_read_b128 v[124:127], v10 offset:2048
    ds_read_b128 v[128:131], v10 offset:3072
    ds_read_b128 v[132:135], v10 offset:4096
    ds_read_b128 v[136:139], v11
    s_mov_b32 s32, s80
    s_mov_b32 s33, s81
    s_mov_b32 s34, 0x280000
    s_mov_b32 s35, 0x00020000
    s_lshl_b32 s24, s12, 12
    s_add_u32 s24, s24, 0
    v_add_u32 v10, s24, v1
    s_lshl_b32 s24, s12, 10
    s_add_u32 s24, s24, 32768
    v_add_u32 v11, s24, v1
    s_cmp_eq_u32 s15, 0
    s_cbranch_scc0 L_adr4
    s_add_u32 s24, s16, 1
    s_and_b32 s24, s24, 3
    s_cmp_gt_u32 s16, s24
    s_subb_u32 s25, s16, 0
    s_lshl_b32 s25, s25, 12
    s_mul_i32 s24, s24, 17408
    s_add_u32 s24, s24, s25
    s_add_u32 s24, s24, 73728
    v_add_u32 v9, s24, v1
    ds_read_b128 v[32:35], v9
    ds_read_b128 v[36:39], v9 offset:1024
    ds_read_b128 v[40:43], v9 offset:2048
    ds_read_b128 v[44:47], v9 offset:3072
    s_add_u32 s24, s16, 2
    s_and_b32 s24, s24, 3
    s_cmp_gt_u32 s16, s24
    s_subb_u32 s25, s16, 0
    s_lshl_b32 s25, s25, 12
    s_mul_i32 s24, s24, 17408
    s_add_u32 s24, s24, s25
    s_add_u32 s24, s24, 73728
    v_add_u32 v9, s24, v1
    ds_read_b128 v[48:51], v9
    ds_read_b128 v[52:55], v9 offset:1024
    ds_read_b128 v[56:59], v9 offset:2048
    ds_read_b128 v[60:63], v9 offset:3072
    s_add_u32 s24, s16, 3
    s_and_b32 s24, s24, 3
    s_cmp_gt_u32 s16, s24
    s_subb_u32 s25, s16, 0
    s_lshl_b32 s25, s25, 12
    s_mul_i32 s24, s24, 17408
    s_add_u32 s24, s24, s25
    s_add_u32 s24, s24, 73728
    v_add_u32 v9, s24, v1
    ds_read_b128 v[84:87], v9
    ds_read_b128 v[88:91], v9 offset:1024
    ds_read_b128 v[92:95], v9 offset:2048
    ds_read_b128 v[96:99], v9 offset:3072
    s_mul_i32 s24, s36, 40960
    s_mul_i32 s25, s37, 320
    s_add_u32 s24, s24, s25
    s_lshl_b32 s25, s41, 6
    s_add_u32 s24, s24, s25
    v_and_b32 v14, 31, v0
    v_mul_u32_u24 v14, 1280, v14
    v_lshrrev_b32 v15, 5, v0
    v_lshlrev_b32 v15, 4, v15
    v_add3_u32 v14, v14, v15, s24
    s_lshl_b32 s24, s42, 10
    s_add_u32 s24, s24, 0
    v_add_u32 v15, s24, v1
    s_lshl_b32 s24, s12, 12
    s_add_u32 s24, s24, 40960
    v_add_u32 v2, s24, v1
    v_add_u32 v3, 2048, v2
    s_waitcnt lgkmcnt(4)
    v_pk_add_f32 v[32:33], v[32:33], v[48:49]
    v_pk_add_f32 v[34:35], v[34:35], v[50:51]
    v_pk_add_f32 v[36:37], v[36:37], v[52:53]
    v_pk_add_f32 v[38:39], v[38:39], v[54:55]
    v_pk_add_f32 v[40:41], v[40:41], v[56:57]
    v_pk_add_f32 v[42:43], v[42:43], v[58:59]
    v_pk_add_f32 v[44:45], v[44:45], v[60:61]
    v_pk_add_f32 v[46:47], v[46:47], v[62:63]
    s_waitcnt lgkmcnt(0)
    v_pk_add_f32 v[32:33], v[32:33], v[84:85]
    v_pk_add_f32 v[34:35], v[34:35], v[86:87]
    v_pk_add_f32 v[36:37], v[36:37], v[88:89]
    v_pk_add_f32 v[38:39], v[38:39], v[90:91]
    v_pk_add_f32 v[40:41], v[40:41], v[92:93]
    v_pk_add_f32 v[42:43], v[42:43], v[94:95]
    v_pk_add_f32 v[44:45], v[44:45], v[96:97]
    v_pk_add_f32 v[46:47], v[46:47], v[98:99]
    s_branch L_adrd
L_adr4:
    s_mul_i32 s24, s16, 17408
    s_add_u32 s24, s24, 86016
    v_add_u32 v9, s24, v1
    ds_read_b128 v[32:35], v9
    ds_read_b128 v[36:39], v9 offset:1024
    ds_read_b128 v[40:43], v9 offset:2048
    ds_read_b128 v[44:47], v9 offset:3072
    s_mul_i32 s24, s36, 40960
    s_mul_i32 s25, s37, 320
    s_add_u32 s24, s24, s25
    s_lshl_b32 s25, s41, 6
    s_add_u32 s24, s24, s25
    v_and_b32 v14, 31, v0
    v_mul_u32_u24 v14, 1280, v14
    v_lshrrev_b32 v15, 5, v0
    v_lshlrev_b32 v15, 3, v15
    v_add3_u32 v14, v14, v15, s24
    s_lshl_b32 s24, s42, 10
    s_add_u32 s24, s24, 0
    v_add_u32 v15, s24, v1
    v_add_u32 v2, 57344, v1
L_adrd:
    s_mov_b32 s43, 0
    s_waitcnt vmcnt(0) lgkmcnt(0)
    v_max3_u32 v9, v64, v65, v66
    v_max3_u32 v9, v9, v67, v68
    v_max3_u32 v9, v9, v69, v70
    v_max3_u32 v9, v9, v71, v72
    v_max3_u32 v9, v9, v73, v74
    v_max3_u32 v9, v9, v75, v76
    v_max3_u32 v9, v9, v77, v78
    v_max3_u32 v9, v9, v79, v80
    v_max3_u32 v9, v9, v81, v82
    v_max_u32 v9, v9, v83
    v_cmp_eq_u32 vcc, -1, v9
    s_nop 0
    s_cmp_eq_u64 vcc, 0
    s_cbranch_scc1 L_poll_ok
    s_mov_b32 s43, 0
L_poll:
    buffer_load_dwordx4 v[64:67], v1, s[8:11], s38 offen sc1
    buffer_load_dwordx4 v[68:71], v1, s[8:11], s38 offen offset:1024 sc1
    buffer_load_dwordx4 v[72:75], v1, s[8:11], s38 offen offset:2048 sc1
    buffer_load_dwordx4 v[76:79], v1, s[8:11], s38 offen offset:3072 sc1
    buffer_load_dwordx2 v[80:81], v8, s[8:11], s44 offen sc1
    buffer_load_dwordx2 v[82:83], v8, s[8:11], s44 offen offset:256 sc1
    s_add_u32 s43, s43, 1
    s_waitcnt vmcnt(0)
    v_max3_u32 v9, v64, v65, v66
    v_max3_u32 v9, v9, v67, v68
    v_max3_u32 v9, v9, v69, v70
    v_max3_u32 v9, v9, v71, v72
    v_max3_u32 v9, v9, v73, v74
    v_max3_u32 v9, v9, v75, v76
    v_max3_u32 v9, v9, v77, v78
    v_max3_u32 v9, v9, v79, v80
    v_max3_u32 v9, v9, v81, v82
    v_max_u32 v9, v9, v83
    v_cmp_eq_u32 vcc, -1, v9
    s_nop 0
    s_cmp_eq_u64 vcc, 0
    s_cbranch_scc1 L_poll_ok
    s_cmp_lt_u32 s43, 32768
    s_cbranch_scc1 L_poll
L_poll_ok:
    ds_write_b128 v10, v[64:67]
    ds_write_b128 v10, v[68:71] offset:1024
    ds_write_b128 v10, v[72:75] offset:2048
    ds_write_b128 v10, v[76:79] offset:3072
    ds_write_b128 v11, v[80:83]
    s_waitcnt lgkmcnt(0)
    s_barrier
    s_waitcnt vmcnt(0)
    s_cmp_eq_u32 s15, 0
    s_cbranch_scc0 L_job4
    ds_read_b128 v[48:51], v15
    ds_read_b128 v[52:55], v15 offset:1024
    ds_read_b128 v[56:59], v15 offset:2048
    ds_read_b128 v[60:63], v15 offset:3072
    s_waitcnt lgkmcnt(3)
    v_mfma_f32_32x32x16_bf16 v[32:47], v[150:153], v[48:51], v[32:47]
    ds_read_b128 v[64:67], v15 offset:4096
    s_waitcnt lgkmcnt(3)
    v_mfma_f32_32x32x16_bf16 v[32:47], v[154:157], v[52:55], v[32:47]
    ds_read_b128 v[68:71], v15 offset:5120
    s_waitcnt lgkmcnt(3)
    v_mfma_f32_32x32x16_bf16 v[32:47], v[158:161], v[56:59], v[32:47]
    ds_read_b128 v[72:75], v15 offset:6144
    s_waitcnt lgkmcnt(3)
    v_mfma_f32_32x32x16_bf16 v[32:47], v[162:165], v[60:63], v[32:47]
    ds_read_b128 v[76:79], v15 offset:7168
    s_waitcnt lgkmcnt(3)
    v_mfma_f32_32x32x16_bf16 v[32:47], v[116:119], v[64:67], v[32:47]
    s_waitcnt lgkmcnt(2)
    v_mfma_f32_32x32x16_bf16 v[32:47], v[120:123], v[68:71], v[32:47]
    s_waitcnt lgkmcnt(1)
    v_mfma_f32_32x32x16_bf16 v[32:47], v[124:127], v[72:75], v[32:47]
    s_waitcnt lgkmcnt(0)
    v_mfma_f32_32x32x16_bf16 v[32:47], v[128:131], v[76:79], v[32:47]
    s_nop 11
    ds_write_b128 v2, v[32:35]
    ds_write_b128 v2, v[36:39] offset:1024
    ds_write_b128 v2, v[40:43] offset:2048
    ds_write_b128 v2, v[44:47] offset:3072
    s_waitcnt lgkmcnt(0)
    s_barrier
    s_branch L_end
L_job4:
    s_cmp_eq_u32 s16, 0
    s_cbranch_scc0 L_job4_1
    ds_read_b128 v[48:51], v15
    ds_read_b128 v[52:55], v15 offset:1024
    ds_read_b128 v[56:59], v15 offset:2048
    ds_read_b128 v[60:63], v15 offset:3072
    s_waitcnt lgkmcnt(3)
    v_mfma_f32_32x32x16_bf16 v[32:47], v[150:153], v[48:51], v[32:47]
    ds_read_b128 v[64:67], v15 offset:4096
    s_waitcnt lgkmcnt(3)
    v_mfma_f32_32x32x16_bf16 v[32:47], v[154:157], v[52:55], v[32:47]
    ds_read_b128 v[68:71], v15 offset:5120
    s_waitcnt lgkmcnt(3)
    v_mfma_f32_32x32x16_bf16 v[32:47], v[158:161], v[56:59], v[32:47]
    ds_read_b128 v[72:75], v15 offset:6144
    s_waitcnt lgkmcnt(3)
    v_mfma_f32_32x32x16_bf16 v[32:47], v[162:165], v[60:63], v[32:47]
    ds_read_b128 v[76:79], v15 offset:7168
    s_waitcnt lgkmcnt(3)
    v_mfma_f32_32x32x16_bf16 v[32:47], v[116:119], v[64:67], v[32:47]
    ds_read_b128 v[48:51], v15 offset:8192
    s_waitcnt lgkmcnt(3)
    v_mfma_f32_32x32x16_bf16 v[32:47], v[120:123], v[68:71], v[32:47]
    ds_read_b128 v[52:55], v15 offset:9216
    s_waitcnt lgkmcnt(3)
    v_mfma_f32_32x32x16_bf16 v[32:47], v[124:127], v[72:75], v[32:47]
    s_waitcnt lgkmcnt(2)
    v_mfma_f32_32x32x16_bf16 v[32:47], v[128:131], v[76:79], v[32:47]
    s_waitcnt lgkmcnt(1)
    v_mfma_f32_32x32x16_bf16 v[32:47], v[132:135], v[48:51], v[32:47]
    s_waitcnt lgkmcnt(0)
    v_mfma_f32_32x32x16_bf16 v[32:47], v[136:139], v[52:55], v[32:47]
    s_nop 11
    ds_write_b128 v2, v[36:39] offset:4096
    ds_write_b128 v2, v[40:43] offset:8192
    ds_write_b128 v2, v[44:47] offset:12288
    s_waitcnt lgkmcnt(0)
    s_barrier
    ds_read_b128 v[48:51], v2 offset:1024
    ds_read_b128 v[52:55], v2 offset:2048
    ds_read_b128 v[56:59], v2 offset:3072
    s_waitcnt lgkmcnt(2)
    v_pk_add_f32 v[32:33], v[32:33], v[48:49]
    v_pk_add_f32 v[34:35], v[34:35], v[50:51]
    s_waitcnt lgkmcnt(1)
    v_pk_add_f32 v[32:33], v[32:33], v[52:53]
    v_pk_add_f32 v[34:35], v[34:35], v[54:55]
    s_waitcnt lgkmcnt(0)
    v_pk_add_f32 v[32:33], v[32:33], v[56:57]
    v_pk_add_f32 v[34:35], v[34:35], v[58:59]
    v_cvt_pk_bf16_f32 v60, v32, v33
    v_cvt_pk_bf16_f32 v61, v34, v35
    buffer_store_dwordx2 v[60:61], v14, s[32:35], 0 offen
    s_branch L_end
L_job4_1:
    s_cmp_eq_u32 s16, 1
    s_cbranch_scc0 L_job4_2
    ds_read_b128 v[48:51], v15
    ds_read_b128 v[52:55], v15 offset:1024
    ds_read_b128 v[56:59], v15 offset:2048
    ds_read_b128 v[60:63], v15 offset:3072
    s_waitcnt lgkmcnt(3)
    v_mfma_f32_32x32x16_bf16 v[32:47], v[150:153], v[48:51], v[32:47]
    ds_read_b128 v[64:67], v15 offset:4096
    s_waitcnt lgkmcnt(3)
    v_mfma_f32_32x32x16_bf16 v[32:47], v[154:157], v[52:55], v[32:47]
    ds_read_b128 v[68:71], v15 offset:5120
    s_waitcnt lgkmcnt(3)
    v_mfma_f32_32x32x16_bf16 v[32:47], v[158:161], v[56:59], v[32:47]
    ds_read_b128 v[72:75], v15 offset:6144
    s_waitcnt lgkmcnt(3)
    v_mfma_f32_32x32x16_bf16 v[32:47], v[162:165], v[60:63], v[32:47]
    ds_read_b128 v[76:79], v15 offset:7168
    s_waitcnt lgkmcnt(3)
    v_mfma_f32_32x32x16_bf16 v[32:47], v[116:119], v[64:67], v[32:47]
    ds_read_b128 v[48:51], v15 offset:8192
    s_waitcnt lgkmcnt(3)
    v_mfma_f32_32x32x16_bf16 v[32:47], v[120:123], v[68:71], v[32:47]
    ds_read_b128 v[52:55], v15 offset:9216
    s_waitcnt lgkmcnt(3)
    v_mfma_f32_32x32x16_bf16 v[32:47], v[124:127], v[72:75], v[32:47]
    s_waitcnt lgkmcnt(2)
    v_mfma_f32_32x32x16_bf16 v[32:47], v[128:131], v[76:79], v[32:47]
    s_waitcnt lgkmcnt(1)
    v_mfma_f32_32x32x16_bf16 v[32:47], v[132:135], v[48:51], v[32:47]
    s_waitcnt lgkmcnt(0)
    v_mfma_f32_32x32x16_bf16 v[32:47], v[136:139], v[52:55], v[32:47]
    s_nop 11
    ds_write_b128 v2, v[32:35] offset:1024
    ds_write_b128 v2, v[40:43] offset:9216
    ds_write_b128 v2, v[44:47] offset:13312
    s_waitcnt lgkmcnt(0)
    s_barrier
    ds_read_b128 v[48:51], v2 offset:4096
    ds_read_b128 v[52:55], v2 offset:6144
    ds_read_b128 v[56:59], v2 offset:7168
    s_waitcnt lgkmcnt(2)
    v_pk_add_f32 v[36:37], v[36:37], v[48:49]
    v_pk_add_f32 v[38:39], v[38:39], v[50:51]
    s_waitcnt lgkmcnt(1)
    v_pk_add_f32 v[36:37], v[36:37], v[52:53]
    v_pk_add_f32 v[38:39], v[38:39], v[54:55]
    s_waitcnt lgkmcnt(0)
    v_pk_add_f32 v[36:37], v[36:37], v[56:57]
    v_pk_add_f32 v[38:39], v[38:39], v[58:59]
    v_cvt_pk_bf16_f32 v60, v36, v37
    v_cvt_pk_bf16_f32 v61, v38, v39
    buffer_store_dwordx2 v[60:61], v14, s[32:35], 0 offen offset:16
    s_branch L_end
L_job4_2:
    s_cmp_eq_u32 s16, 2
    s_cbranch_scc0 L_job4_3
    ds_read_b128 v[48:51], v15
    ds_read_b128 v[52:55], v15 offset:1024
    ds_read_b128 v[56:59], v15 offset:2048
    ds_read_b128 v[60:63], v15 offset:3072
    s_waitcnt lgkmcnt(3)
    v_mfma_f32_32x32x16_bf16 v[32:47], v[150:153], v[48:51], v[32:47]
    ds_read_b128 v[64:67], v15 offset:4096
    s_waitcnt lgkmcnt(3)
    v_mfma_f32_32x32x16_bf16 v[32:47], v[154:157], v[52:55], v[32:47]
    ds_read_b128 v[68:71], v15 offset:5120
    s_waitcnt lgkmcnt(3)
    v_mfma_f32_32x32x16_bf16 v[32:47], v[158:161], v[56:59], v[32:47]
    ds_read_b128 v[72:75], v15 offset:6144
    s_waitcnt lgkmcnt(3)
    v_mfma_f32_32x32x16_bf16 v[32:47], v[162:165], v[60:63], v[32:47]
    ds_read_b128 v[76:79], v15 offset:7168
    s_waitcnt lgkmcnt(3)
    v_mfma_f32_32x32x16_bf16 v[32:47], v[116:119], v[64:67], v[32:47]
    ds_read_b128 v[48:51], v15 offset:8192
    s_waitcnt lgkmcnt(3)
    v_mfma_f32_32x32x16_bf16 v[32:47], v[120:123], v[68:71], v[32:47]
    ds_read_b128 v[52:55], v15 offset:9216
    s_waitcnt lgkmcnt(3)
    v_mfma_f32_32x32x16_bf16 v[32:47], v[124:127], v[72:75], v[32:47]
    s_waitcnt lgkmcnt(2)
    v_mfma_f32_32x32x16_bf16 v[32:47], v[128:131], v[76:79], v[32:47]
    s_waitcnt lgkmcnt(1)
    v_mfma_f32_32x32x16_bf16 v[32:47], v[132:135], v[48:51], v[32:47]
    s_waitcnt lgkmcnt(0)
    v_mfma_f32_32x32x16_bf16 v[32:47], v[136:139], v[52:55], v[32:47]
    s_nop 11
    ds_write_b128 v2, v[32:35] offset:2048
    ds_write_b128 v2, v[36:39] offset:6144
    ds_write_b128 v2, v[44:47] offset:14336
    s_waitcnt lgkmcnt(0)
    s_barrier
    ds_read_b128 v[48:51], v2 offset:8192
    ds_read_b128 v[52:55], v2 offset:9216
    ds_read_b128 v[56:59], v2 offset:11264
    s_waitcnt lgkmcnt(2)
    v_pk_add_f32 v[40:41], v[40:41], v[48:49]
    v_pk_add_f32 v[42:43], v[42:43], v[50:51]
    s_waitcnt lgkmcnt(1)
    v_pk_add_f32 v[40:41], v[40:41], v[52:53]
    v_pk_add_f32 v[42:43], v[42:43], v[54:55]
    s_waitcnt lgkmcnt(0)
    v_pk_add_f32 v[40:41], v[40:41], v[56:57]
    v_pk_add_f32 v[42:43], v[42:43], v[58:59]
    v_cvt_pk_bf16_f32 v60, v40, v41
    v_cvt_pk_bf16_f32 v61, v42, v43
    buffer_store_dwordx2 v[60:61], v14, s[32:35], 0 offen offset:32
    s_branch L_end
L_job4_3:
    ds_read_b128 v[48:51], v15
    ds_read_b128 v[52:55], v15 offset:1024
    ds_read_b128 v[56:59], v15 offset:2048
    ds_read_b128 v[60:63], v15 offset:3072
    s_waitcnt lgkmcnt(3)
    v_mfma_f32_32x32x16_bf16 v[32:47], v[150:153], v[48:51], v[32:47]
    ds_read_b128 v[64:67], v15 offset:4096
    s_waitcnt lgkmcnt(3)
    v_mfma_f32_32x32x16_bf16 v[32:47], v[154:157], v[52:55], v[32:47]
    ds_read_b128 v[68:71], v15 offset:5120
    s_waitcnt lgkmcnt(3)
    v_mfma_f32_32x32x16_bf16 v[32:47], v[158:161], v[56:59], v[32:47]
    ds_read_b128 v[72:75], v15 offset:6144
    s_waitcnt lgkmcnt(3)
    v_mfma_f32_32x32x16_bf16 v[32:47], v[162:165], v[60:63], v[32:47]
    ds_read_b128 v[76:79], v15 offset:7168
    s_waitcnt lgkmcnt(3)
    v_mfma_f32_32x32x16_bf16 v[32:47], v[116:119], v[64:67], v[32:47]
    ds_read_b128 v[48:51], v15 offset:8192
    s_waitcnt lgkmcnt(3)
    v_mfma_f32_32x32x16_bf16 v[32:47], v[120:123], v[68:71], v[32:47]
    ds_read_b128 v[52:55], v15 offset:9216
    s_waitcnt lgkmcnt(3)
    v_mfma_f32_32x32x16_bf16 v[32:47], v[124:127], v[72:75], v[32:47]
    s_waitcnt lgkmcnt(2)
    v_mfma_f32_32x32x16_bf16 v[32:47], v[128:131], v[76:79], v[32:47]
    s_waitcnt lgkmcnt(1)
    v_mfma_f32_32x32x16_bf16 v[32:47], v[132:135], v[48:51], v[32:47]
    s_waitcnt lgkmcnt(0)
    v_mfma_f32_32x32x16_bf16 v[32:47], v[136:139], v[52:55], v[32:47]
    s_nop 11
    ds_write_b128 v2, v[32:35] offset:3072
    ds_write_b128 v2, v[36:39] offset:7168
    ds_write_b128 v2, v[40:43] offset:11264
    s_waitcnt lgkmcnt(0)
    s_barrier
    ds_read_b128 v[48:51], v2 offset:12288
    ds_read_b128 v[52:55], v2 offset:13312
    ds_read_b128 v[56:59], v2 offset:14336
    s_waitcnt lgkmcnt(2)
    v_pk_add_f32 v[44:45], v[44:45], v[48:49]
    v_pk_add_f32 v[46:47], v[46:47], v[50:51]
    s_waitcnt lgkmcnt(1)
    v_pk_add_f32 v[44:45], v[44:45], v[52:53]
    v_pk_add_f32 v[46:47], v[46:47], v[54:55]
    s_waitcnt lgkmcnt(0)
    v_pk_add_f32 v[44:45], v[44:45], v[56:57]
    v_pk_add_f32 v[46:47], v[46:47], v[58:59]
    v_cvt_pk_bf16_f32 v60, v44, v45
    v_cvt_pk_bf16_f32 v61, v46, v47
    buffer_store_dwordx2 v[60:61], v14, s[32:35], 0 offen offset:48
L_end:
    s_endpgm
L_wl:
    buffer_load_dword v148, v149, s[8:11], s18 offen sc1
    buffer_load_dwordx4 v[150:153], v1, s[8:11], s39 offen sc1
    s_add_u32 s39, s39, 5120
    buffer_load_dwordx4 v[154:157], v1, s[8:11], s39 offen sc1
    s_add_u32 s39, s39, 5120
    buffer_load_dwordx4 v[158:161], v1, s[8:11], s39 offen sc1
    s_add_u32 s39, s39, 5120
    buffer_load_dwordx4 v[162:165], v1, s[8:11], s39 offen sc1
    s_add_u32 s39, s39, 5120
    s_branch L_wl_ret
L_B_help:
    s_mul_i32 s24, s16, 320
    v_add_u32 v20, 0, v0
    v_mul_u32_u24 v21, 3277, v20
    v_lshrrev_b32 v21, 16, v21
    v_mul_u32_u24 v22, 20, v21
    v_sub_u32 v20, v20, v22
    v_lshlrev_b32 v20, 4, v20
    v_add_u32 v20, s24, v20
    v_mul_u32_u24 v22, 1280, v21
    v_add_u32 v24, v20, v22
    v_bfe_u32 v22, v21, 2, 1
    v_mul_u32_u24 v22, 40, v22
    v_lshrrev_b32 v23, 3, v21
    v_mul_u32_u24 v23, 20, v23
    v_and_b32 v21, 3, v21
    v_add3_u32 v22, v22, v23, v21
    v_add_u32 v22, 16, v22
    v_mul_u32_u24 v22, 1280, v22
    v_add_u32 v29, v20, v22
    v_add_u32 v20, 64, v0
    v_mul_u32_u24 v21, 3277, v20
    v_lshrrev_b32 v21, 16, v21
    v_mul_u32_u24 v22, 20, v21
    v_sub_u32 v20, v20, v22
    v_lshlrev_b32 v20, 4, v20
    v_add_u32 v20, s24, v20
    v_subrev_u32 v20, 1024, v20
    v_mul_u32_u24 v22, 1280, v21
    v_add_u32 v25, v20, v22
    v_bfe_u32 v22, v21, 2, 1
    v_mul_u32_u24 v22, 40, v22
    v_lshrrev_b32 v23, 3, v21
    v_mul_u32_u24 v23, 20, v23
    v_and_b32 v21, 3, v21
    v_add3_u32 v22, v22, v23, v21
    v_add_u32 v22, 16, v22
    v_mul_u32_u24 v22, 1280, v22
    v_add_u32 v30, v20, v22
    v_add_u32 v20, 128, v0
    v_mul_u32_u24 v21, 3277, v20
    v_lshrrev_b32 v21, 16, v21
    v_mul_u32_u24 v22, 20, v21
    v_sub_u32 v20, v20, v22
    v_lshlrev_b32 v20, 4, v20
    v_add_u32 v20, s24, v20
    v_subrev_u32 v20, 2048, v20
    v_mul_u32_u24 v22, 1280, v21
    v_add_u32 v26, v20, v22
    v_bfe_u32 v22, v21, 2, 1
    v_mul_u32_u24 v22, 40, v22
    v_lshrrev_b32 v23, 3, v21
    v_mul_u32_u24 v23, 20, v23
    v_and_b32 v21, 3, v21
    v_add3_u32 v22, v22, v23, v21
    v_add_u32 v22, 16, v22
    v_mul_u32_u24 v22, 1280, v22
    v_add_u32 v31, v20, v22
    v_add_u32 v20, 192, v0
    v_mul_u32_u24 v21, 3277, v20
    v_lshrrev_b32 v21, 16, v21
    v_mul_u32_u24 v22, 20, v21
    v_sub_u32 v20, v20, v22
    v_lshlrev_b32 v20, 4, v20
    v_add_u32 v20, s24, v20
    v_subrev_u32 v20, 3072, v20
    v_mul_u32_u24 v22, 1280, v21
    v_add_u32 v27, v20, v22
    v_bfe_u32 v22, v21, 2, 1
    v_mul_u32_u24 v22, 40, v22
    v_lshrrev_b32 v23, 3, v21
    v_mul_u32_u24 v23, 20, v23
    v_and_b32 v21, 3, v21
    v_add3_u32 v22, v22, v23, v21
    v_add_u32 v22, 16, v22
    v_mul_u32_u24 v22, 1280, v22
    v_add_u32 v32, v20, v22
    v_add_u32 v20, 256, v0
    v_mul_u32_u24 v21, 3277, v20
    v_lshrrev_b32 v21, 16, v21
    v_mul_u32_u24 v22, 20, v21
    v_sub_u32 v20, v20, v22
    v_lshlrev_b32 v20, 4, v20
    v_add_u32 v20, s24, v20
    v_mul_u32_u24 v22, 1280, v21
    v_add_u32 v28, v20, v22
    v_bfe_u32 v22, v21, 2, 1
    v_mul_u32_u24 v22, 40, v22
    v_lshrrev_b32 v23, 3, v21
    v_mul_u32_u24 v23, 20, v23
    v_and_b32 v21, 3, v21
    v_add3_u32 v22, v22, v23, v21
    v_add_u32 v22, 16, v22
    v_mul_u32_u24 v22, 1280, v22
    v_add_u32 v33, v20, v22
    s_mul_i32 s19, s16, 12800
    s_add_u32 s19, s19, 98304
    s_mul_i32 s38, s16, 5120
    s_add_u32 s38, s38, 65536
    s_mov_b32 s52, s76
    s_mov_b32 s53, s77
    s_mov_b32 s54, 0x21c000
    s_mov_b32 s55, 0x00020000
    s_mul_i32 s90, s29, 20480
    s_add_u32 s90, s90, 819200
    s_mov_b32 s56, s78
    s_mov_b32 s57, s79
    s_mov_b32 s58, 0x500
    s_mov_b32 s59, 0x00020000
    s_lshl_b32 s26, s16, 11
    s_add_u32 s26, s26, 149504
    s_mov_b32 m0, s26
    s_mov_b32 s25, 0
    buffer_load_dwordx4 v1, s[56:59], s25 offen lds
    buffer_load_dwordx4 v1, s[56:59], s25 offen offset:1024 lds
    v_lshrrev_b32 v20, 5, v0
    v_bfe_u32 v21, v0, 2, 2
    v_lshl_add_u32 v20, v20, 2, v21
    v_mul_u32_u24 v20, 320, v20
    v_bfe_u32 v21, v0, 4, 1
    v_lshlrev_b32 v21, 5, v21
    v_and_b32 v22, 3, v0
    v_lshlrev_b32 v22, 3, v22
    v_add3_u32 v35, v20, v21, v22
    v_add_u32 v36, s38, v35
    v_add_u32 v35, s19, v35
    s_mul_i32 s39, s16, 148
    s_add_u32 s39, s39, s29
    s_mul_i32 s39, s39, 5120
    s_add_u32 s39, s39, 0x1400000
    s_lshr_b32 s3, s2, 6
    s_lshl_b32 s3, s3, 2
    s_lshr_b32 s21, 0x0, s3
    s_and_b32 s21, s21, 15
    s_add_u32 s21, s21, s14
    s_and_b32 s3, s2, 7
    s_add_u32 s21, s21, s3
    s_cmp_ge_u32 s21, 10
    s_cselect_b32 s3, 10, 0
    s_sub_u32 s21, s21, s3
    s_cmp_ge_u32 s21, 10
    s_cselect_b32 s3, 10, 0
    s_sub_u32 s21, s21, s3
    s_lshl_b32 s62, s21, 7
    s_lshl_b32 s24, s16, 13
    v_add_u32 v37, s24, v1
    v_add_u32 v38, 65536, v37
    v_and_b32 v20, 7, v0
    v_lshrrev_b32 v21, 4, v0
    v_xor_b32 v20, v20, v21
    v_lshl_add_u32 v39, v20, 4, s26
    v_mov_b32 v120, 0
    v_mov_b32 v121, 0
    v_mov_b32 v122, 0
    v_mov_b32 v123, 0
    v_mov_b32 v124, 0
    v_mov_b32 v125, 0
    v_mov_b32 v126, 0
    v_mov_b32 v127, 0
    s_waitcnt vmcnt(0)
    s_barrier
    v_add_u32 v20, s62, v39
    v_xor_b32 v21, 64, v20
    ds_read_b128 v[112:115], v20
    ds_read_b128 v[116:119], v21
    ds_read_b128 v[80:83], v37
    ds_read_b128 v[84:87], v37 offset:1024
    ds_read_b128 v[88:91], v37 offset:2048
    ds_read_b128 v[92:95], v37 offset:3072
    ds_read_b128 v[96:99], v37 offset:4096
    ds_read_b128 v[100:103], v37 offset:5120
    ds_read_b128 v[104:107], v37 offset:6144
    ds_read_b128 v[108:111], v37 offset:7168
    s_add_u32 s62, s62, 128
    s_cmp_eq_u32 s62, 1280
    s_cselect_b32 s62, 0, s62
    s_sub_u32 s90, s90, 819200
    s_mov_b32 m0, s19
    s_add_u32 s25, s19, 4096
    buffer_load_dwordx4 v24, s[52:55], s90 offen lds
    buffer_load_dwordx4 v25, s[52:55], s90 offen offset:1024 lds
    buffer_load_dwordx4 v26, s[52:55], s90 offen offset:2048 lds
    buffer_load_dwordx4 v27, s[52:55], s90 offen offset:3072 lds
    s_mov_b32 m0, s25
    s_nop 0
    buffer_load_dwordx4 v28, s[52:55], s90 offen lds
    s_add_u32 s90, s90, 819200
    s_waitcnt lgkmcnt(0)
    s_barrier
    v_dot2_f32_bf16 v120, v80, v112, v120
    v_dot2_f32_bf16 v121, v84, v116, v121
    v_dot2_f32_bf16 v122, v88, v112, v122
    v_dot2_f32_bf16 v123, v92, v116, v123
    v_dot2_f32_bf16 v124, v96, v112, v124
    v_dot2_f32_bf16 v125, v100, v116, v125
    v_dot2_f32_bf16 v126, v104, v112, v126
    v_dot2_f32_bf16 v127, v108, v116, v127
    v_dot2_f32_bf16 v120, v81, v113, v120
    v_dot2_f32_bf16 v121, v85, v117, v121
    v_dot2_f32_bf16 v122, v89, v113, v122
    v_dot2_f32_bf16 v123, v93, v117, v123
    v_dot2_f32_bf16 v124, v97, v113, v124
    v_dot2_f32_bf16 v125, v101, v117, v125
    v_dot2_f32_bf16 v126, v105, v113, v126
    v_dot2_f32_bf16 v127, v109, v117, v127
    v_dot2_f32_bf16 v120, v82, v114, v120
    v_dot2_f32_bf16 v121, v86, v118, v121
    v_dot2_f32_bf16 v122, v90, v114, v122
    v_dot2_f32_bf16 v123, v94, v118, v123
    v_dot2_f32_bf16 v124, v98, v114, v124
    v_dot2_f32_bf16 v125, v102, v118, v125
    v_dot2_f32_bf16 v126, v106, v114, v126
    v_dot2_f32_bf16 v127, v110, v118, v127
    v_dot2_f32_bf16 v120, v83, v115, v120
    v_dot2_f32_bf16 v121, v87, v119, v121
    v_dot2_f32_bf16 v122, v91, v115, v122
    v_dot2_f32_bf16 v123, v95, v119, v123
    v_dot2_f32_bf16 v124, v99, v115, v124
    v_dot2_f32_bf16 v125, v103, v119, v125
    v_dot2_f32_bf16 v126, v107, v115, v126
    v_dot2_f32_bf16 v127, v111, v119, v127
    s_barrier
    v_add_u32 v20, s62, v39
    v_xor_b32 v21, 64, v20
    ds_read_b128 v[112:115], v20
    ds_read_b128 v[116:119], v21
    ds_read_b128 v[80:83], v37 offset:32768
    ds_read_b128 v[84:87], v37 offset:33792
    ds_read_b128 v[88:91], v37 offset:34816
    ds_read_b128 v[92:95], v37 offset:35840
    ds_read_b128 v[96:99], v37 offset:36864
    ds_read_b128 v[100:103], v37 offset:37888
    ds_read_b128 v[104:107], v37 offset:38912
    ds_read_b128 v[108:111], v37 offset:39936
    s_add_u32 s62, s62, 128
    s_cmp_eq_u32 s62, 1280
    s_cselect_b32 s62, 0, s62
    s_waitcnt vmcnt(0)
    ds_read_b64_tr_b16 v[40:41], v35
    ds_read_b64_tr_b16 v[42:43], v35 offset:2560
    ds_read_b64_tr_b16 v[44:45], v35 offset:64
    ds_read_b64_tr_b16 v[46:47], v35 offset:2624
    ds_read_b64_tr_b16 v[48:49], v35 offset:128
    ds_read_b64_tr_b16 v[50:51], v35 offset:2688
    ds_read_b64_tr_b16 v[52:53], v35 offset:192
    ds_read_b64_tr_b16 v[54:55], v35 offset:2752
    ds_read_b64_tr_b16 v[56:57], v35 offset:256
    ds_read_b64_tr_b16 v[58:59], v35 offset:2816
    s_waitcnt lgkmcnt(0)
    s_mov_b32 m0, s19
    s_add_u32 s25, s19, 4096
    buffer_load_dwordx4 v24, s[52:55], s90 offen lds
    buffer_load_dwordx4 v25, s[52:55], s90 offen offset:1024 lds
    buffer_load_dwordx4 v26, s[52:55], s90 offen offset:2048 lds
    buffer_load_dwordx4 v27, s[52:55], s90 offen offset:3072 lds
    s_mov_b32 m0, s25
    s_nop 0
    buffer_load_dwordx4 v28, s[52:55], s90 offen lds
    s_add_u32 s25, s39, 4096
    buffer_store_dwordx4 v[40:43], v1, s[8:11], s39 offen sc1
    buffer_store_dwordx4 v[44:47], v1, s[8:11], s39 offen offset:1024 sc1
    buffer_store_dwordx4 v[48:51], v1, s[8:11], s39 offen offset:2048 sc1
    buffer_store_dwordx4 v[52:55], v1, s[8:11], s39 offen offset:3072 sc1
    buffer_store_dwordx4 v[56:59], v1, s[8:11], s25 offen sc1
    s_add_u32 s39, s39, 204800
    s_waitcnt lgkmcnt(0)
    s_barrier
    v_dot2_f32_bf16 v120, v80, v112, v120
    v_dot2_f32_bf16 v121, v84, v116, v121
    v_dot2_f32_bf16 v122, v88, v112, v122
    v_dot2_f32_bf16 v123, v92, v116, v123
    v_dot2_f32_bf16 v124, v96, v112, v124
    v_dot2_f32_bf16 v125, v100, v116, v125
    v_dot2_f32_bf16 v126, v104, v112, v126
    v_dot2_f32_bf16 v127, v108, v116, v127
    v_dot2_f32_bf16 v120, v81, v113, v120
    v_dot2_f32_bf16 v121, v85, v117, v121
    v_dot2_f32_bf16 v122, v89, v113, v122
    v_dot2_f32_bf16 v123, v93, v117, v123
    v_dot2_f32_bf16 v124, v97, v113, v124
    v_dot2_f32_bf16 v125, v101, v117, v125
    v_dot2_f32_bf16 v126, v105, v113, v126
    v_dot2_f32_bf16 v127, v109, v117, v127
    v_dot2_f32_bf16 v120, v82, v114, v120
    v_dot2_f32_bf16 v121, v86, v118, v121
    v_dot2_f32_bf16 v122, v90, v114, v122
    v_dot2_f32_bf16 v123, v94, v118, v123
    v_dot2_f32_bf16 v124, v98, v114, v124
    v_dot2_f32_bf16 v125, v102, v118, v125
    v_dot2_f32_bf16 v126, v106, v114, v126
    v_dot2_f32_bf16 v127, v110, v118, v127
    v_dot2_f32_bf16 v120, v83, v115, v120
    v_dot2_f32_bf16 v121, v87, v119, v121
    v_dot2_f32_bf16 v122, v91, v115, v122
    v_dot2_f32_bf16 v123, v95, v119, v123
    v_dot2_f32_bf16 v124, v99, v115, v124
    v_dot2_f32_bf16 v125, v103, v119, v125
    v_dot2_f32_bf16 v126, v107, v115, v126
    v_dot2_f32_bf16 v127, v111, v119, v127
    s_barrier
    v_add_u32 v20, s62, v39
    v_xor_b32 v21, 64, v20
    ds_read_b128 v[112:115], v20
    ds_read_b128 v[116:119], v21
    ds_read_b128 v[80:83], v38
    ds_read_b128 v[84:87], v38 offset:1024
    ds_read_b128 v[88:91], v38 offset:2048
    ds_read_b128 v[92:95], v38 offset:3072
    ds_read_b128 v[96:99], v38 offset:4096
    ds_read_b128 v[100:103], v38 offset:5120
    ds_read_b128 v[104:107], v38 offset:6144
    ds_read_b128 v[108:111], v38 offset:7168
    s_add_u32 s62, s62, 128
    s_cmp_eq_u32 s62, 1280
    s_cselect_b32 s62, 0, s62
    s_waitcnt lgkmcnt(0)
    s_barrier
    v_dot2_f32_bf16 v120, v80, v112, v120
    v_dot2_f32_bf16 v121, v84, v116, v121
    v_dot2_f32_bf16 v122, v88, v112, v122
    v_dot2_f32_bf16 v123, v92, v116, v123
    v_dot2_f32_bf16 v124, v96, v112, v124
    v_dot2_f32_bf16 v125, v100, v116, v125
    v_dot2_f32_bf16 v126, v104, v112, v126
    v_dot2_f32_bf16 v127, v108, v116, v127
    v_dot2_f32_bf16 v120, v81, v113, v120
    v_dot2_f32_bf16 v121, v85, v117, v121
    v_dot2_f32_bf16 v122, v89, v113, v122
    v_dot2_f32_bf16 v123, v93, v117, v123
    v_dot2_f32_bf16 v124, v97, v113, v124
    v_dot2_f32_bf16 v125, v101, v117, v125
    v_dot2_f32_bf16 v126, v105, v113, v126
    v_dot2_f32_bf16 v127, v109, v117, v127
    v_dot2_f32_bf16 v120, v82, v114, v120
    v_dot2_f32_bf16 v121, v86, v118, v121
    v_dot2_f32_bf16 v122, v90, v114, v122
    v_dot2_f32_bf16 v123, v94, v118, v123
    v_dot2_f32_bf16 v124, v98, v114, v124
    v_dot2_f32_bf16 v125, v102, v118, v125
    v_dot2_f32_bf16 v126, v106, v114, v126
    v_dot2_f32_bf16 v127, v110, v118, v127
    v_dot2_f32_bf16 v120, v83, v115, v120
    v_dot2_f32_bf16 v121, v87, v119, v121
    v_dot2_f32_bf16 v122, v91, v115, v122
    v_dot2_f32_bf16 v123, v95, v119, v123
    v_dot2_f32_bf16 v124, v99, v115, v124
    v_dot2_f32_bf16 v125, v103, v119, v125
    v_dot2_f32_bf16 v126, v107, v115, v126
    v_dot2_f32_bf16 v127, v111, v119, v127
    s_barrier
    v_add_u32 v20, s62, v39
    v_xor_b32 v21, 64, v20
    ds_read_b128 v[112:115], v20
    ds_read_b128 v[116:119], v21
    ds_read_b128 v[80:83], v37
    ds_read_b128 v[84:87], v37 offset:1024
    ds_read_b128 v[88:91], v37 offset:2048
    ds_read_b128 v[92:95], v37 offset:3072
    ds_read_b128 v[96:99], v37 offset:4096
    ds_read_b128 v[100:103], v37 offset:5120
    ds_read_b128 v[104:107], v37 offset:6144
    ds_read_b128 v[108:111], v37 offset:7168
    s_add_u32 s62, s62, 128
    s_cmp_eq_u32 s62, 1280
    s_cselect_b32 s62, 0, s62
    s_waitcnt vmcnt(5)
    ds_read_b64_tr_b16 v[60:61], v35
    ds_read_b64_tr_b16 v[62:63], v35 offset:2560
    ds_read_b64_tr_b16 v[64:65], v35 offset:64
    ds_read_b64_tr_b16 v[66:67], v35 offset:2624
    ds_read_b64_tr_b16 v[68:69], v35 offset:128
    ds_read_b64_tr_b16 v[70:71], v35 offset:2688
    ds_read_b64_tr_b16 v[72:73], v35 offset:192
    ds_read_b64_tr_b16 v[74:75], v35 offset:2752
    ds_read_b64_tr_b16 v[76:77], v35 offset:256
    ds_read_b64_tr_b16 v[78:79], v35 offset:2816
    s_cmp_lt_u32 s29, 28
    s_cbranch_scc1 L_h2a
    s_mov_b32 s52, s68
    s_mov_b32 s53, s69
    s_mov_b32 s54, 0xc8000
    s_mov_b32 s55, 0x00020000
    s_sub_u32 s90, s29, 28
    s_mul_i32 s90, s90, 25600
    s_branch L_h2b
L_h2a:
    s_add_u32 s90, s90, 819200
L_h2b:
    s_waitcnt lgkmcnt(0)
    s_mov_b32 m0, s19
    s_add_u32 s25, s19, 4096
    buffer_load_dwordx4 v24, s[52:55], s90 offen lds
    buffer_load_dwordx4 v25, s[52:55], s90 offen offset:1024 lds
    buffer_load_dwordx4 v26, s[52:55], s90 offen offset:2048 lds
    buffer_load_dwordx4 v27, s[52:55], s90 offen offset:3072 lds
    s_mov_b32 m0, s25
    s_nop 0
    buffer_load_dwordx4 v28, s[52:55], s90 offen lds
    s_add_u32 s25, s39, 4096
    buffer_store_dwordx4 v[60:63], v1, s[8:11], s39 offen sc1
    buffer_store_dwordx4 v[64:67], v1, s[8:11], s39 offen offset:1024 sc1
    buffer_store_dwordx4 v[68:71], v1, s[8:11], s39 offen offset:2048 sc1
    buffer_store_dwordx4 v[72:75], v1, s[8:11], s39 offen offset:3072 sc1
    buffer_store_dwordx4 v[76:79], v1, s[8:11], s25 offen sc1
    s_add_u32 s39, s39, 204800
    s_waitcnt lgkmcnt(0)
    s_barrier
    v_dot2_f32_bf16 v120, v80, v112, v120
    v_dot2_f32_bf16 v121, v84, v116, v121
    v_dot2_f32_bf16 v122, v88, v112, v122
    v_dot2_f32_bf16 v123, v92, v116, v123
    v_dot2_f32_bf16 v124, v96, v112, v124
    v_dot2_f32_bf16 v125, v100, v116, v125
    v_dot2_f32_bf16 v126, v104, v112, v126
    v_dot2_f32_bf16 v127, v108, v116, v127
    v_dot2_f32_bf16 v120, v81, v113, v120
    v_dot2_f32_bf16 v121, v85, v117, v121
    v_dot2_f32_bf16 v122, v89, v113, v122
    v_dot2_f32_bf16 v123, v93, v117, v123
    v_dot2_f32_bf16 v124, v97, v113, v124
    v_dot2_f32_bf16 v125, v101, v117, v125
    v_dot2_f32_bf16 v126, v105, v113, v126
    v_dot2_f32_bf16 v127, v109, v117, v127
    v_dot2_f32_bf16 v120, v82, v114, v120
    v_dot2_f32_bf16 v121, v86, v118, v121
    v_dot2_f32_bf16 v122, v90, v114, v122
    v_dot2_f32_bf16 v123, v94, v118, v123
    v_dot2_f32_bf16 v124, v98, v114, v124
    v_dot2_f32_bf16 v125, v102, v118, v125
    v_dot2_f32_bf16 v126, v106, v114, v126
    v_dot2_f32_bf16 v127, v110, v118, v127
    v_dot2_f32_bf16 v120, v83, v115, v120
    v_dot2_f32_bf16 v121, v87, v119, v121
    v_dot2_f32_bf16 v122, v91, v115, v122
    v_dot2_f32_bf16 v123, v95, v119, v123
    v_dot2_f32_bf16 v124, v99, v115, v124
    v_dot2_f32_bf16 v125, v103, v119, v125
    v_dot2_f32_bf16 v126, v107, v115, v126
    v_dot2_f32_bf16 v127, v111, v119, v127
    s_barrier
    v_add_u32 v20, s62, v39
    v_xor_b32 v21, 64, v20
    ds_read_b128 v[112:115], v20
    ds_read_b128 v[116:119], v21
    ds_read_b128 v[80:83], v37 offset:32768
    ds_read_b128 v[84:87], v37 offset:33792
    ds_read_b128 v[88:91], v37 offset:34816
    ds_read_b128 v[92:95], v37 offset:35840
    ds_read_b128 v[96:99], v37 offset:36864
    ds_read_b128 v[100:103], v37 offset:37888
    ds_read_b128 v[104:107], v37 offset:38912
    ds_read_b128 v[108:111], v37 offset:39936
    s_add_u32 s62, s62, 128
    s_cmp_eq_u32 s62, 1280
    s_cselect_b32 s62, 0, s62
    s_waitcnt lgkmcnt(0)
    s_barrier
    v_dot2_f32_bf16 v120, v80, v112, v120
    v_dot2_f32_bf16 v121, v84, v116, v121
    v_dot2_f32_bf16 v122, v88, v112, v122
    v_dot2_f32_bf16 v123, v92, v116, v123
    v_dot2_f32_bf16 v124, v96, v112, v124
    v_dot2_f32_bf16 v125, v100, v116, v125
    v_dot2_f32_bf16 v126, v104, v112, v126
    v_dot2_f32_bf16 v127, v108, v116, v127
    v_dot2_f32_bf16 v120, v81, v113, v120
    v_dot2_f32_bf16 v121, v85, v117, v121
    v_dot2_f32_bf16 v122, v89, v113, v122
    v_dot2_f32_bf16 v123, v93, v117, v123
    v_dot2_f32_bf16 v124, v97, v113, v124
    v_dot2_f32_bf16 v125, v101, v117, v125
    v_dot2_f32_bf16 v126, v105, v113, v126
    v_dot2_f32_bf16 v127, v109, v117, v127
    v_dot2_f32_bf16 v120, v82, v114, v120
    v_dot2_f32_bf16 v121, v86, v118, v121
    v_dot2_f32_bf16 v122, v90, v114, v122
    v_dot2_f32_bf16 v123, v94, v118, v123
    v_dot2_f32_bf16 v124, v98, v114, v124
    v_dot2_f32_bf16 v125, v102, v118, v125
    v_dot2_f32_bf16 v126, v106, v114, v126
    v_dot2_f32_bf16 v127, v110, v118, v127
    v_dot2_f32_bf16 v120, v83, v115, v120
    v_dot2_f32_bf16 v121, v87, v119, v121
    v_dot2_f32_bf16 v122, v91, v115, v122
    v_dot2_f32_bf16 v123, v95, v119, v123
    v_dot2_f32_bf16 v124, v99, v115, v124
    v_dot2_f32_bf16 v125, v103, v119, v125
    v_dot2_f32_bf16 v126, v107, v115, v126
    v_dot2_f32_bf16 v127, v111, v119, v127
    s_barrier
    v_add_u32 v20, s62, v39
    v_xor_b32 v21, 64, v20
    ds_read_b128 v[112:115], v20
    ds_read_b128 v[116:119], v21
    ds_read_b128 v[80:83], v38
    ds_read_b128 v[84:87], v38 offset:1024
    ds_read_b128 v[88:91], v38 offset:2048
    ds_read_b128 v[92:95], v38 offset:3072
    ds_read_b128 v[96:99], v38 offset:4096
    ds_read_b128 v[100:103], v38 offset:5120
    ds_read_b128 v[104:107], v38 offset:6144
    ds_read_b128 v[108:111], v38 offset:7168
    s_add_u32 s62, s62, 128
    s_cmp_eq_u32 s62, 1280
    s_cselect_b32 s62, 0, s62
    s_waitcnt vmcnt(5)
    ds_read_b64_tr_b16 v[40:41], v35
    ds_read_b64_tr_b16 v[42:43], v35 offset:2560
    ds_read_b64_tr_b16 v[44:45], v35 offset:64
    ds_read_b64_tr_b16 v[46:47], v35 offset:2624
    ds_read_b64_tr_b16 v[48:49], v35 offset:128
    ds_read_b64_tr_b16 v[50:51], v35 offset:2688
    ds_read_b64_tr_b16 v[52:53], v35 offset:192
    ds_read_b64_tr_b16 v[54:55], v35 offset:2752
    ds_read_b64_tr_b16 v[56:57], v35 offset:256
    ds_read_b64_tr_b16 v[58:59], v35 offset:2816
    s_mov_b32 s52, s68
    s_mov_b32 s53, s69
    s_mov_b32 s54, 0xc8000
    s_mov_b32 s55, 0x00020000
    s_waitcnt lgkmcnt(0)
    s_cmp_lt_u32 s29, 20
    s_cbranch_scc0 L_h3b
    s_add_u32 s90, s29, 12
    s_mul_i32 s90, s90, 25600
    s_mov_b32 m0, s19
    s_add_u32 s25, s19, 4096
    buffer_load_dwordx4 v24, s[52:55], s90 offen lds
    buffer_load_dwordx4 v25, s[52:55], s90 offen offset:1024 lds
    buffer_load_dwordx4 v26, s[52:55], s90 offen offset:2048 lds
    buffer_load_dwordx4 v27, s[52:55], s90 offen offset:3072 lds
    s_mov_b32 m0, s25
    s_nop 0
    buffer_load_dwordx4 v28, s[52:55], s90 offen lds
    s_branch L_h3d
L_h3b:
    s_cmp_lt_u32 s29, 28
    s_cbranch_scc0 L_h3d
    s_sub_u32 s90, s29, 20
    s_mul_i32 s90, s90, 102400
    s_mov_b32 m0, s19
    s_add_u32 s25, s19, 4096
    buffer_load_dwordx4 v29, s[52:55], s90 offen lds
    buffer_load_dwordx4 v30, s[52:55], s90 offen offset:1024 lds
    buffer_load_dwordx4 v31, s[52:55], s90 offen offset:2048 lds
    buffer_load_dwordx4 v32, s[52:55], s90 offen offset:3072 lds
    s_mov_b32 m0, s25
    s_nop 0
    buffer_load_dwordx4 v33, s[52:55], s90 offen lds
L_h3d:
    s_add_u32 s25, s39, 4096
    buffer_store_dwordx4 v[40:43], v1, s[8:11], s39 offen sc1
    buffer_store_dwordx4 v[44:47], v1, s[8:11], s39 offen offset:1024 sc1
    buffer_store_dwordx4 v[48:51], v1, s[8:11], s39 offen offset:2048 sc1
    buffer_store_dwordx4 v[52:55], v1, s[8:11], s39 offen offset:3072 sc1
    buffer_store_dwordx4 v[56:59], v1, s[8:11], s25 offen sc1
    s_add_u32 s39, s39, 204800
    s_waitcnt lgkmcnt(0)
    s_barrier
    v_dot2_f32_bf16 v120, v80, v112, v120
    v_dot2_f32_bf16 v121, v84, v116, v121
    v_dot2_f32_bf16 v122, v88, v112, v122
    v_dot2_f32_bf16 v123, v92, v116, v123
    v_dot2_f32_bf16 v124, v96, v112, v124
    v_dot2_f32_bf16 v125, v100, v116, v125
    v_dot2_f32_bf16 v126, v104, v112, v126
    v_dot2_f32_bf16 v127, v108, v116, v127
    v_dot2_f32_bf16 v120, v81, v113, v120
    v_dot2_f32_bf16 v121, v85, v117, v121
    v_dot2_f32_bf16 v122, v89, v113, v122
    v_dot2_f32_bf16 v123, v93, v117, v123
    v_dot2_f32_bf16 v124, v97, v113, v124
    v_dot2_f32_bf16 v125, v101, v117, v125
    v_dot2_f32_bf16 v126, v105, v113, v126
    v_dot2_f32_bf16 v127, v109, v117, v127
    v_dot2_f32_bf16 v120, v82, v114, v120
    v_dot2_f32_bf16 v121, v86, v118, v121
    v_dot2_f32_bf16 v122, v90, v114, v122
    v_dot2_f32_bf16 v123, v94, v118, v123
    v_dot2_f32_bf16 v124, v98, v114, v124
    v_dot2_f32_bf16 v125, v102, v118, v125
    v_dot2_f32_bf16 v126, v106, v114, v126
    v_dot2_f32_bf16 v127, v110, v118, v127
    v_dot2_f32_bf16 v120, v83, v115, v120
    v_dot2_f32_bf16 v121, v87, v119, v121
    v_dot2_f32_bf16 v122, v91, v115, v122
    v_dot2_f32_bf16 v123, v95, v119, v123
    v_dot2_f32_bf16 v124, v99, v115, v124
    v_dot2_f32_bf16 v125, v103, v119, v125
    v_dot2_f32_bf16 v126, v107, v115, v126
    v_dot2_f32_bf16 v127, v111, v119, v127
    s_barrier
    v_add_u32 v20, s62, v39
    v_xor_b32 v21, 64, v20
    ds_read_b128 v[112:115], v20
    ds_read_b128 v[116:119], v21
    ds_read_b128 v[80:83], v37
    ds_read_b128 v[84:87], v37 offset:1024
    ds_read_b128 v[88:91], v37 offset:2048
    ds_read_b128 v[92:95], v37 offset:3072
    ds_read_b128 v[96:99], v37 offset:4096
    ds_read_b128 v[100:103], v37 offset:5120
    ds_read_b128 v[104:107], v37 offset:6144
    ds_read_b128 v[108:111], v37 offset:7168
    s_add_u32 s62, s62, 128
    s_cmp_eq_u32 s62, 1280
    s_cselect_b32 s62, 0, s62
    s_waitcnt lgkmcnt(0)
    s_barrier
    v_dot2_f32_bf16 v120, v80, v112, v120
    v_dot2_f32_bf16 v121, v84, v116, v121
    v_dot2_f32_bf16 v122, v88, v112, v122
    v_dot2_f32_bf16 v123, v92, v116, v123
    v_dot2_f32_bf16 v124, v96, v112, v124
    v_dot2_f32_bf16 v125, v100, v116, v125
    v_dot2_f32_bf16 v126, v104, v112, v126
    v_dot2_f32_bf16 v127, v108, v116, v127
    v_dot2_f32_bf16 v120, v81, v113, v120
    v_dot2_f32_bf16 v121, v85, v117, v121
    v_dot2_f32_bf16 v122, v89, v113, v122
    v_dot2_f32_bf16 v123, v93, v117, v123
    v_dot2_f32_bf16 v124, v97, v113, v124
    v_dot2_f32_bf16 v125, v101, v117, v125
    v_dot2_f32_bf16 v126, v105, v113, v126
    v_dot2_f32_bf16 v127, v109, v117, v127
    v_dot2_f32_bf16 v120, v82, v114, v120
    v_dot2_f32_bf16 v121, v86, v118, v121
    v_dot2_f32_bf16 v122, v90, v114, v122
    v_dot2_f32_bf16 v123, v94, v118, v123
    v_dot2_f32_bf16 v124, v98, v114, v124
    v_dot2_f32_bf16 v125, v102, v118, v125
    v_dot2_f32_bf16 v126, v106, v114, v126
    v_dot2_f32_bf16 v127, v110, v118, v127
    v_dot2_f32_bf16 v120, v83, v115, v120
    v_dot2_f32_bf16 v121, v87, v119, v121
    v_dot2_f32_bf16 v122, v91, v115, v122
    v_dot2_f32_bf16 v123, v95, v119, v123
    v_dot2_f32_bf16 v124, v99, v115, v124
    v_dot2_f32_bf16 v125, v103, v119, v125
    v_dot2_f32_bf16 v126, v107, v115, v126
    v_dot2_f32_bf16 v127, v111, v119, v127
    s_barrier
    v_add_u32 v20, s62, v39
    v_xor_b32 v21, 64, v20
    ds_read_b128 v[112:115], v20
    ds_read_b128 v[116:119], v21
    ds_read_b128 v[80:83], v37 offset:32768
    ds_read_b128 v[84:87], v37 offset:33792
    ds_read_b128 v[88:91], v37 offset:34816
    ds_read_b128 v[92:95], v37 offset:35840
    ds_read_b128 v[96:99], v37 offset:36864
    ds_read_b128 v[100:103], v37 offset:37888
    ds_read_b128 v[104:107], v37 offset:38912
    ds_read_b128 v[108:111], v37 offset:39936
    s_add_u32 s62, s62, 128
    s_cmp_eq_u32 s62, 1280
    s_cselect_b32 s62, 0, s62
    s_cmp_lt_u32 s29, 28
    s_cbranch_scc0 L_h4d
    s_waitcnt vmcnt(5)
    ds_read_b64_tr_b16 v[60:61], v35
    ds_read_b64_tr_b16 v[62:63], v35 offset:2560
    ds_read_b64_tr_b16 v[64:65], v35 offset:64
    ds_read_b64_tr_b16 v[66:67], v35 offset:2624
    ds_read_b64_tr_b16 v[68:69], v35 offset:128
    ds_read_b64_tr_b16 v[70:71], v35 offset:2688
    ds_read_b64_tr_b16 v[72:73], v35 offset:192
    ds_read_b64_tr_b16 v[74:75], v35 offset:2752
    ds_read_b64_tr_b16 v[76:77], v35 offset:256
    ds_read_b64_tr_b16 v[78:79], v35 offset:2816
    s_waitcnt lgkmcnt(0)
    s_add_u32 s25, s39, 4096
    buffer_store_dwordx4 v[60:63], v1, s[8:11], s39 offen sc1
    buffer_store_dwordx4 v[64:67], v1, s[8:11], s39 offen offset:1024 sc1
    buffer_store_dwordx4 v[68:71], v1, s[8:11], s39 offen offset:2048 sc1
    buffer_store_dwordx4 v[72:75], v1, s[8:11], s39 offen offset:3072 sc1
    buffer_store_dwordx4 v[76:79], v1, s[8:11], s25 offen sc1
    s_add_u32 s39, s39, 204800
L_h4d:
    s_waitcnt lgkmcnt(0)
    s_barrier
    v_dot2_f32_bf16 v120, v80, v112, v120
    v_dot2_f32_bf16 v121, v84, v116, v121
    v_dot2_f32_bf16 v122, v88, v112, v122
    v_dot2_f32_bf16 v123, v92, v116, v123
    v_dot2_f32_bf16 v124, v96, v112, v124
    v_dot2_f32_bf16 v125, v100, v116, v125
    v_dot2_f32_bf16 v126, v104, v112, v126
    v_dot2_f32_bf16 v127, v108, v116, v127
    v_dot2_f32_bf16 v120, v81, v113, v120
    v_dot2_f32_bf16 v121, v85, v117, v121
    v_dot2_f32_bf16 v122, v89, v113, v122
    v_dot2_f32_bf16 v123, v93, v117, v123
    v_dot2_f32_bf16 v124, v97, v113, v124
    v_dot2_f32_bf16 v125, v101, v117, v125
    v_dot2_f32_bf16 v126, v105, v113, v126
    v_dot2_f32_bf16 v127, v109, v117, v127
    v_dot2_f32_bf16 v120, v82, v114, v120
    v_dot2_f32_bf16 v121, v86, v118, v121
    v_dot2_f32_bf16 v122, v90, v114, v122
    v_dot2_f32_bf16 v123, v94, v118, v123
    v_dot2_f32_bf16 v124, v98, v114, v124
    v_dot2_f32_bf16 v125, v102, v118, v125
    v_dot2_f32_bf16 v126, v106, v114, v126
    v_dot2_f32_bf16 v127, v110, v118, v127
    v_dot2_f32_bf16 v120, v83, v115, v120
    v_dot2_f32_bf16 v121, v87, v119, v121
    v_dot2_f32_bf16 v122, v91, v115, v122
    v_dot2_f32_bf16 v123, v95, v119, v123
    v_dot2_f32_bf16 v124, v99, v115, v124
    v_dot2_f32_bf16 v125, v103, v119, v125
    v_dot2_f32_bf16 v126, v107, v115, v126
    v_dot2_f32_bf16 v127, v111, v119, v127
    s_barrier
    v_add_u32 v20, s62, v39
    v_xor_b32 v21, 64, v20
    ds_read_b128 v[112:115], v20
    ds_read_b128 v[116:119], v21
    ds_read_b128 v[80:83], v38
    ds_read_b128 v[84:87], v38 offset:1024
    ds_read_b128 v[88:91], v38 offset:2048
    ds_read_b128 v[92:95], v38 offset:3072
    ds_read_b128 v[96:99], v38 offset:4096
    ds_read_b128 v[100:103], v38 offset:5120
    ds_read_b128 v[104:107], v38 offset:6144
    ds_read_b128 v[108:111], v38 offset:7168
    s_add_u32 s62, s62, 128
    s_cmp_eq_u32 s62, 1280
    s_cselect_b32 s62, 0, s62
    s_waitcnt lgkmcnt(0)
    s_barrier
    v_dot2_f32_bf16 v120, v80, v112, v120
    v_dot2_f32_bf16 v121, v84, v116, v121
    v_dot2_f32_bf16 v122, v88, v112, v122
    v_dot2_f32_bf16 v123, v92, v116, v123
    v_dot2_f32_bf16 v124, v96, v112, v124
    v_dot2_f32_bf16 v125, v100, v116, v125
    v_dot2_f32_bf16 v126, v104, v112, v126
    v_dot2_f32_bf16 v127, v108, v116, v127
    v_dot2_f32_bf16 v120, v81, v113, v120
    v_dot2_f32_bf16 v121, v85, v117, v121
    v_dot2_f32_bf16 v122, v89, v113, v122
    v_dot2_f32_bf16 v123, v93, v117, v123
    v_dot2_f32_bf16 v124, v97, v113, v124
    v_dot2_f32_bf16 v125, v101, v117, v125
    v_dot2_f32_bf16 v126, v105, v113, v126
    v_dot2_f32_bf16 v127, v109, v117, v127
    v_dot2_f32_bf16 v120, v82, v114, v120
    v_dot2_f32_bf16 v121, v86, v118, v121
    v_dot2_f32_bf16 v122, v90, v114, v122
    v_dot2_f32_bf16 v123, v94, v118, v123
    v_dot2_f32_bf16 v124, v98, v114, v124
    v_dot2_f32_bf16 v125, v102, v118, v125
    v_dot2_f32_bf16 v126, v106, v114, v126
    v_dot2_f32_bf16 v127, v110, v118, v127
    v_dot2_f32_bf16 v120, v83, v115, v120
    v_dot2_f32_bf16 v121, v87, v119, v121
    v_dot2_f32_bf16 v122, v91, v115, v122
    v_dot2_f32_bf16 v123, v95, v119, v123
    v_dot2_f32_bf16 v124, v99, v115, v124
    v_dot2_f32_bf16 v125, v103, v119, v125
    v_dot2_f32_bf16 v126, v107, v115, v126
    v_dot2_f32_bf16 v127, v111, v119, v127
    s_barrier
    v_add_u32 v20, s62, v39
    v_xor_b32 v21, 64, v20
    ds_read_b128 v[112:115], v20
    ds_read_b128 v[116:119], v21
    ds_read_b128 v[80:83], v37
    ds_read_b128 v[84:87], v37 offset:1024
    ds_read_b128 v[88:91], v37 offset:2048
    ds_read_b128 v[92:95], v37 offset:3072
    ds_read_b128 v[96:99], v37 offset:4096
    ds_read_b128 v[100:103], v37 offset:5120
    ds_read_b128 v[104:107], v37 offset:6144
    ds_read_b128 v[108:111], v37 offset:7168
    s_add_u32 s62, s62, 128
    s_cmp_eq_u32 s62, 1280
    s_cselect_b32 s62, 0, s62
    s_waitcnt lgkmcnt(0)
    s_barrier
    v_dot2_f32_bf16 v120, v80, v112, v120
    v_dot2_f32_bf16 v121, v84, v116, v121
    v_dot2_f32_bf16 v122, v88, v112, v122
    v_dot2_f32_bf16 v123, v92, v116, v123
    v_dot2_f32_bf16 v124, v96, v112, v124
    v_dot2_f32_bf16 v125, v100, v116, v125
    v_dot2_f32_bf16 v126, v104, v112, v126
    v_dot2_f32_bf16 v127, v108, v116, v127
    v_dot2_f32_bf16 v120, v81, v113, v120
    v_dot2_f32_bf16 v121, v85, v117, v121
    v_dot2_f32_bf16 v122, v89, v113, v122
    v_dot2_f32_bf16 v123, v93, v117, v123
    v_dot2_f32_bf16 v124, v97, v113, v124
    v_dot2_f32_bf16 v125, v101, v117, v125
    v_dot2_f32_bf16 v126, v105, v113, v126
    v_dot2_f32_bf16 v127, v109, v117, v127
    v_dot2_f32_bf16 v120, v82, v114, v120
    v_dot2_f32_bf16 v121, v86, v118, v121
    v_dot2_f32_bf16 v122, v90, v114, v122
    v_dot2_f32_bf16 v123, v94, v118, v123
    v_dot2_f32_bf16 v124, v98, v114, v124
    v_dot2_f32_bf16 v125, v102, v118, v125
    v_dot2_f32_bf16 v126, v106, v114, v126
    v_dot2_f32_bf16 v127, v110, v118, v127
    v_dot2_f32_bf16 v120, v83, v115, v120
    v_dot2_f32_bf16 v121, v87, v119, v121
    v_dot2_f32_bf16 v122, v91, v115, v122
    v_dot2_f32_bf16 v123, v95, v119, v123
    v_dot2_f32_bf16 v124, v99, v115, v124
    v_dot2_f32_bf16 v125, v103, v119, v125
    v_dot2_f32_bf16 v126, v107, v115, v126
    v_dot2_f32_bf16 v127, v111, v119, v127
    s_barrier
    s_nop 1
    v_add_f32 v120, v120, v120 quad_perm:[1,0,3,2] row_mask:0xf bank_mask:0xf
    v_add_f32 v121, v121, v121 quad_perm:[1,0,3,2] row_mask:0xf bank_mask:0xf
    v_add_f32 v122, v122, v122 quad_perm:[1,0,3,2] row_mask:0xf bank_mask:0xf
    v_add_f32 v123, v123, v123 quad_perm:[1,0,3,2] row_mask:0xf bank_mask:0xf
    v_add_f32 v124, v124, v124 quad_perm:[1,0,3,2] row_mask:0xf bank_mask:0xf
    v_add_f32 v125, v125, v125 quad_perm:[1,0,3,2] row_mask:0xf bank_mask:0xf
    v_add_f32 v126, v126, v126 quad_perm:[1,0,3,2] row_mask:0xf bank_mask:0xf
    v_add_f32 v127, v127, v127 quad_perm:[1,0,3,2] row_mask:0xf bank_mask:0xf
    s_nop 1
    v_add_f32 v120, v120, v120 quad_perm:[2,3,0,1] row_mask:0xf bank_mask:0xf
    v_add_f32 v121, v121, v121 quad_perm:[2,3,0,1] row_mask:0xf bank_mask:0xf
    v_add_f32 v122, v122, v122 quad_perm:[2,3,0,1] row_mask:0xf bank_mask:0xf
    v_add_f32 v123, v123, v123 quad_perm:[2,3,0,1] row_mask:0xf bank_mask:0xf
    v_add_f32 v124, v124, v124 quad_perm:[2,3,0,1] row_mask:0xf bank_mask:0xf
    v_add_f32 v125, v125, v125 quad_perm:[2,3,0,1] row_mask:0xf bank_mask:0xf
    v_add_f32 v126, v126, v126 quad_perm:[2,3,0,1] row_mask:0xf bank_mask:0xf
    v_add_f32 v127, v127, v127 quad_perm:[2,3,0,1] row_mask:0xf bank_mask:0xf
    s_nop 1
    v_add_f32 v120, v120, v120 row_half_mirror row_mask:0xf bank_mask:0xf
    v_add_f32 v121, v121, v121 row_half_mirror row_mask:0xf bank_mask:0xf
    v_add_f32 v122, v122, v122 row_half_mirror row_mask:0xf bank_mask:0xf
    v_add_f32 v123, v123, v123 row_half_mirror row_mask:0xf bank_mask:0xf
    v_add_f32 v124, v124, v124 row_half_mirror row_mask:0xf bank_mask:0xf
    v_add_f32 v125, v125, v125 row_half_mirror row_mask:0xf bank_mask:0xf
    v_add_f32 v126, v126, v126 row_half_mirror row_mask:0xf bank_mask:0xf
    v_add_f32 v127, v127, v127 row_half_mirror row_mask:0xf bank_mask:0xf
    v_and_b32 v20, 7, v0
    v_cmp_eq_u32 vcc, 1, v20
    s_nop 0
    v_cndmask_b32 v120, v120, v121, vcc
    v_cmp_eq_u32 vcc, 2, v20
    s_nop 0
    v_cndmask_b32 v120, v120, v122, vcc
    v_cmp_eq_u32 vcc, 3, v20
    s_nop 0
    v_cndmask_b32 v120, v120, v123, vcc
    v_cmp_eq_u32 vcc, 4, v20
    s_nop 0
    v_cndmask_b32 v120, v120, v124, vcc
    v_cmp_eq_u32 vcc, 5, v20
    s_nop 0
    v_cndmask_b32 v120, v120, v125, vcc
    v_cmp_eq_u32 vcc, 6, v20
    s_nop 0
    v_cndmask_b32 v120, v120, v126, vcc
    v_cmp_eq_u32 vcc, 7, v20
    s_nop 0
    v_cndmask_b32 v120, v120, v127, vcc
    v_mul_f32 v120, 0xbfb8aa3b, v120
    v_exp_f32 v120, v120
    v_lshlrev_b32 v20, 5, v20
    v_lshrrev_b32 v21, 3, v0
    v_add_f32 v120, 1.0, v120
    v_rcp_f32 v120, v120
    v_lshl_add_u32 v20, v21, 2, v20
    s_lshl_b32 s24, s14, 2
    s_add_u32 s24, s24, s16
    s_lshl_b32 s24, s24, 8
    s_add_u32 s24, s24, 0x1800000
    s_cmp_eq_u32 s20, 27
    s_cselect_b32 s24, s24, 0x40000000
    buffer_store_dword v120, v20, s[8:11], s24 offen sc1
    s_lshl_b32 s24, s16, 6
    s_add_u32 s24, s24, s29
    s_lshl_b32 s24, s24, 7
    s_add_u32 s24, s24, 0x1a40000
    v_mov_b32 v20, 0
    v_mov_b32 v21, 1
    s_waitcnt vmcnt(0)
    s_mov_b64 exec, 1
    buffer_store_dword v21, v20, s[8:11], s24 offen sc1
    s_mov_b64 exec, -1
    s_barrier
    ds_read_b128 v[12:15], v6 offset:49152
    ds_read_b64 v[16:17], v7 offset:0
    ds_read_b128 v[18:21], v6 offset:51840
    ds_read_b64 v[22:23], v7 offset:2688
    s_branch L_B_join
L_slow:
    s_waitcnt vmcnt(0)
    v_mov_b32 v12, v18
    v_mov_b32 v13, v19
    v_mov_b32 v14, v20
    v_mov_b32 v15, v21
    v_mov_b32 v16, v22
    v_mov_b32 v17, v23
L_s0:
    v_cndmask_b32 v16, 0, v16, s[60:61]
    v_cndmask_b32 v17, 0, v17, s[60:61]
    v_and_b32 v8, 31, v0
    v_lshlrev_b32 v3, 3, v8
    v_add_u32 v3, 2432, v3
    v_mov_b32 v9, 1344
    v_cndmask_b32 v3, v9, v3, s[60:61]
    v_min_u32 v8, 21, v8
    v_lshlrev_b32 v8, 4, v8
    v_lshrrev_b32 v9, 5, v0
    v_mul_u32_u24 v9, 352, v9
    v_add_u32 v4, v8, v9
    v_mov_b32 v6, 0xff800000
    s_mul_i32 s17, s13, 196608
    s_mov_b32 s18, s17
    s_mov_b32 s21, 0
L_s1:
    buffer_load_dwordx4 v[24:27], v1, s[8:11], s18 offen sc1
    buffer_load_dwordx2 v[28:29], v3, s[8:11], s18 offen sc1
    s_waitcnt vmcnt(0)
    v_mfma_f32_32x32x8bf16_1k v[84:99], v[28:29], v[16:17], 0
    v_mfma_f32_32x32x16_bf16 v[84:99], v[24:27], v[12:15], v[84:99]
    s_nop 15
    v_max3_f32 v7, v84, v85, v86
    v_max3_f32 v7, v7, v87, v88
    v_max3_f32 v7, v7, v89, v90
    v_max3_f32 v7, v7, v91, v92
    v_max3_f32 v7, v7, v93, v94
    v_max3_f32 v7, v7, v95, v96
    v_max3_f32 v7, v7, v97, v98
    v_max_f32 v7, v7, v99
    v_max_f32 v6, v6, v7
    s_add_u32 s21, s21, 1
    s_and_b32 s24, s21, 7
    s_cselect_b32 s24, 0, 3072
    s_add_u32 s18, s18, s24
    s_add_u32 s18, s18, 2688
    s_cmp_lt_u32 s21, 64
    s_nop 7
    s_cbranch_scc1 L_s1
    v_mov_b32 v7, v6
    s_nop 1
    v_permlane32_swap_b32 v6, v7
    s_nop 1
    v_max_f32 v6, v6, v7
    v_sub_f32 v6, 0, v6
    v_and_b32 v7, 0xffff0000, v6
    v_sub_f32 v6, v6, v7
    v_and_b32 v8, 0xffff0000, v6
    v_sub_f32 v6, v6, v8
    v_lshrrev_b32 v7, 16, v7
    v_or_b32 v7, v7, v8
    v_lshrrev_b32 v6, 16, v6
    v_cndmask_b32 v16, v7, v16, s[60:61]
    v_cndmask_b32 v17, v6, v17, s[60:61]
    v_mov_b32 v52, 0
    v_mov_b32 v53, 0
    v_mov_b32 v54, 0
    v_mov_b32 v55, 0
    v_mov_b32 v56, 0
    v_mov_b32 v57, 0
    v_mov_b32 v58, 0
    v_mov_b32 v59, 0
    v_mov_b32 v60, 0
    v_mov_b32 v61, 0
    v_mov_b32 v62, 0
    v_mov_b32 v63, 0
    v_mov_b32 v64, 0
    v_mov_b32 v65, 0
    v_mov_b32 v66, 0
    v_mov_b32 v67, 0
    s_mov_b32 s18, s17
    s_mov_b32 s21, 0
L_s2:
    buffer_load_dwordx4 v[24:27], v1, s[8:11], s18 offen sc1
    buffer_load_dwordx2 v[28:29], v3, s[8:11], s18 offen sc1
    buffer_load_dwordx4 v[36:39], v4, s[8:11], s18 offen offset:1024 sc1
    buffer_load_dwordx4 v[40:43], v4, s[8:11], s18 offen offset:1728 sc1
    s_waitcnt vmcnt(0)
    v_mfma_f32_32x32x8bf16_1k v[84:99], v[28:29], v[16:17], 0
    v_mfma_f32_32x32x16_bf16 v[84:99], v[24:27], v[12:15], v[84:99]
    s_nop 15
    v_exp_f32 v84, v84
    v_exp_f32 v85, v85
    v_exp_f32 v86, v86
    v_exp_f32 v87, v87
    v_exp_f32 v88, v88
    v_exp_f32 v89, v89
    v_exp_f32 v90, v90
    v_exp_f32 v91, v91
    v_exp_f32 v92, v92
    v_exp_f32 v93, v93
    v_exp_f32 v94, v94
    v_exp_f32 v95, v95
    v_exp_f32 v96, v96
    v_exp_f32 v97, v97
    v_exp_f32 v98, v98
    v_exp_f32 v99, v99
    s_nop 1
    v_smfmac_f32_32x32x32_bf16 v[52:67], v[36:39], v[84:91], v5
    v_smfmac_f32_32x32x32_bf16 v[52:67], v[40:43], v[92:99], v5
    s_add_u32 s21, s21, 1
    s_and_b32 s24, s21, 7
    s_cselect_b32 s24, 0, 3072
    s_add_u32 s18, s18, s24
    s_add_u32 s18, s18, 2688
    s_cmp_lt_u32 s21, 64
    s_nop 7
    s_cbranch_scc1 L_s2
    s_nop 15
    v_mov_b32 v6, v60
    v_mov_b32 v7, v60
    s_nop 1
    v_permlane32_swap_b32 v6, v7
    s_nop 1
    v_rcp_f32 v6, v7
    s_mul_i32 s24, s28, 148
    s_lshl_b32 s24, s24, 10
    s_add_u32 s24, s24, 0xa1b000
    s_lshl_b32 s25, s13, 10
    s_add_u32 s25, s25, s24
    s_lshl_b32 s26, s13, 8
    s_add_u32 s24, s24, s26
    s_add_u32 s24, s24, 32768
    v_lshlrev_b32 v42, 3, v0
    v_mul_f32 v6, v6, v148
    v_pk_mul_f32 v[52:53], v[52:53], v[6:7] op_sel_hi:[1,0]
    v_pk_mul_f32 v[54:55], v[54:55], v[6:7] op_sel_hi:[1,0]
    v_pk_mul_f32 v[56:57], v[56:57], v[6:7] op_sel_hi:[1,0]
    v_pk_mul_f32 v[58:59], v[58:59], v[6:7] op_sel_hi:[1,0]
    v_pk_mul_f32 v[60:61], v[60:61], v[6:7] op_sel_hi:[1,0]
    v_pk_mul_f32 v[62:63], v[62:63], v[6:7] op_sel_hi:[1,0]
    v_cvt_pk_bf16_f32 v36, v52, v53
    v_cvt_pk_bf16_f32 v37, v54, v55
    v_cvt_pk_bf16_f32 v38, v56, v57
    v_cvt_pk_bf16_f32 v39, v58, v59
    v_cvt_pk_bf16_f32 v40, v60, v61
    v_cvt_pk_bf16_f32 v41, v62, v63
    v_min_u32 v36, -2, v36
    v_min_u32 v37, -2, v37
    v_min_u32 v38, -2, v38
    v_min_u32 v39, -2, v39
    v_min_u32 v40, -2, v40
    v_min_u32 v41, -2, v41
    s_branch L_st
.section .rodata,"a"
.p2align 6
.amdhsa_kernel kf_kernel
  .amdhsa_next_free_vgpr 168
  .amdhsa_next_free_sgpr 102
  .amdhsa_accum_offset 168
  .amdhsa_group_segment_fixed_size 0
  .amdhsa_kernarg_size 88
  .amdhsa_user_sgpr_count 2
  .amdhsa_user_sgpr_kernarg_segment_ptr 1
  .amdhsa_system_sgpr_workgroup_id_x 1
.end_amdhsa_kernel
.text
```
